```python
import torch

def _softmax(x, axis=-1):
    return torch.softmax(x, dim=axis)
def _gelu(x):
    return torch.nn.functional.gelu(x, approximate="tanh")
def _silu(x):
    return torch.nn.functional.silu(x)
def _sigmoid(x):
    return torch.sigmoid(x)
def _layernorm(x, axis=-1, eps=1e-5):
    m = x.mean(dim=axis, keepdim=True)
    v = x.var(dim=axis, keepdim=True, unbiased=False)
    return (x - m) / torch.sqrt(v + eps)
def _scatter_add(tgt, idx, src, axis=0):
    return tgt.clone().index_add_(axis, idx, src)
def _segment_sum(src, seg, n):
    out = torch.zeros((n,) + src.shape[1:], dtype=src.dtype)
    return out.index_add_(0, seg, src)
def _pad(x, pw):
    flat = tuple(v for pair in reversed(pw) for v in pair)
    return torch.nn.functional.pad(x, flat)

kernel_name = 'parallel_sum__mha_block_cached__geglu_ffn__decode'

def setup_inputs():

    _w = (lambda a: (lambda t: t.to(torch.bfloat16) if t.is_floating_point() else t)(torch.as_tensor(a)))
    def _A_setup():
        B, Sq, D = 4, 1, 576
        H, Sk, Dh = 32, 8192, 128
        return {
            "x": _w((lambda *s: torch.randn(*s, dtype=torch.bfloat16) * 0.05)(B, Sq, D)),
            "k_cache": _w((lambda *s: torch.randn(*s, dtype=torch.bfloat16) * 3.2)(B, H, Sk, Dh)),
            "v_cache": _w((lambda *s: torch.randn(*s, dtype=torch.bfloat16) * 1.6)(B, H, Sk, Dh)),
            "wq": _w((lambda *s: torch.randn(*s, dtype=torch.bfloat16) * 3.2)(D, H * Dh) * (D ** -0.5)),
            "wo": _w((lambda *s: torch.randn(*s, dtype=torch.bfloat16) * 1.6)(H * Dh, D) * ((H * Dh) ** -0.5)),
        }
    _A_in = _A_setup()

    def _B_setup():
        B, S, D, F = 4, 1, 576, 4608
        return {
            "x": _w((lambda *s: torch.randn(*s, dtype=torch.bfloat16) * 0.05)(B, S, D)),
            "w_gate": _w((lambda *s: torch.randn(*s, dtype=torch.bfloat16) * 0.05)(D, F)),
            "w_up": _w((lambda *s: torch.randn(*s, dtype=torch.bfloat16) * 0.05)(D, F)),
            "w_down": _w((lambda *s: torch.randn(*s, dtype=torch.bfloat16) * 0.05)(F, D)),
        }
    _B_in = _B_setup()

    return {
        "A_x": _A_in["x"],
        "A_k_cache": _A_in["k_cache"],
        "A_v_cache": _A_in["v_cache"],
        "A_wq": _A_in["wq"],
        "A_wo": _A_in["wo"],
        "B_x": _B_in["x"],
        "B_w_gate": _B_in["w_gate"],
        "B_w_up": _B_in["w_up"],
        "B_w_down": _B_in["w_down"],
    }

def reference(A_x, A_k_cache, A_v_cache, A_wq, A_wo, B_x, B_w_gate, B_w_up, B_w_down):
    def _A_ref(x, k_cache, v_cache, wq, wo):
        B, Sq, D = x.shape
        H, Dh = 32, 128
        q = (lambda x, *d: x.permute(*d))((x @ wq).reshape(B, Sq, H, Dh), 0, 2, 1, 3)
        scores = torch.einsum("bhqd,bhkd->bhqk", q, k_cache) * (Dh ** -0.5)
        p = _softmax(scores, axis=-1)
        o = torch.einsum("bhqk,bhkd->bhqd", p, v_cache)
        return (lambda x, *d: x.permute(*d))(o, 0, 2, 1, 3).reshape(B, Sq, H * Dh) @ wo

    def _B_ref(x, w_gate, w_up, w_down):
        return (_gelu(x @ w_gate) * (x @ w_up)) @ w_down

    x = A_x
    xn = _layernorm(x, axis=-1)
    return x + _A_ref(xn, A_k_cache, A_v_cache, A_wq, A_wo) + _B_ref(xn, B_w_gate, B_w_up, B_w_down)
```

```asm
; @launch grid=(256,1,1) block=(320,1,1) lds=132352
.amdgcn_target "amdgcn-amd-amdhsa--gfx950"
.text
.globl parallel_sum__mha_block_cached__geglu_ffn__decode_kernel
.p2align 8
.type parallel_sum__mha_block_cached__geglu_ffn__decode_kernel,@function
parallel_sum__mha_block_cached__geglu_ffn__decode_kernel:
  s_cmp_ge_u32 s2, 256
  s_cbranch_scc1 L_end
  s_load_dwordx16 s[36:51], s[0:1], 0
  s_load_dwordx8 s[52:59], s[0:1], 64
  v_lshrrev_b32 v1, 6, v0
  v_and_b32 v0, 63, v0
  v_readfirstlane_b32 s3, v1
  s_lshr_b32 s60, s2, 3
  s_and_b32 s61, s2, 7
  s_add_u32 s63, s61, s60
  s_and_b32 s63, s63, 31
  s_lshl_b32 s86, s61, 5
  s_add_u32 s86, s86, s63
  s_lshr_b32 s87, s86, 3
  s_and_b32 s88, s86, 7
  s_and_b32 s63, s61, 1
  s_lshl_b32 s63, s63, 2
  s_lshr_b32 s64, s61, 1
  s_add_u32 s63, s63, s64
  s_lshl_b32 s86, s60, 3
  s_add_u32 s86, s86, s63
  s_and_b32 s64, s60, 3
  s_cmp_eq_u32 s63, s64
  s_cselect_b32 s77, 1, 0
  s_mov_b32 s74, 0xffff0000
  s_mov_b32 s73, 0x3fb8aa3b
  s_mov_b32 s72, 0x3db504f3
  s_mov_b32 s76, 131072
  s_mov_b32 s84, 0x000f000f
  s_mov_b32 s85, 0x000f000f
  v_and_b32 v1, 15, v0
  v_lshrrev_b32 v2, 4, v0
  s_cmp_eq_u32 s3, 0
  s_cbranch_scc0 L_streamer
  s_setprio 3
  v_mov_b32 v4, 0
  v_mov_b32 v5, 0
  v_mov_b32 v3, 7168
  ds_write_b64 v3, v[4:5]
  ds_write_b64 v3, v[4:5] offset:8
  ds_write_b64 v3, v[4:5] offset:16
  s_and_b32 s92, s86, 3
  s_add_u32 s93, s60, 256
  s_getreg_b32 s101, hwreg(HW_REG_XCC_ID)
  s_lshr_b32 s101, s101, 2
  s_and_b32 s101, s101, 1
  s_lshl_b32 s89, s60, 21
  s_lshl_b32 s64, s61, 8
  s_add_u32 s89, s89, s64
  s_add_u32 s89, s89, 0x1f0000
  s_and_b32 s64, s61, 1
  s_lshl_b32 s64, s64, 13
  s_add_u32 s89, s89, s64
  s_xor_b32 s65, s89, 0x2000
  s_mov_b32 s10, 0x10000000
  s_mov_b32 s11, 0x20000
  s_mov_b32 s14, 0x10000000
  s_mov_b32 s15, 0x20000
  s_bitcmp1_b32 s61, 1
  s_waitcnt lgkmcnt(0)
  s_cselect_b64 s[8:9], s[40:41], s[38:39]
  s_cselect_b64 s[12:13], s[38:39], s[40:41]
  buffer_load_dword v16, v4, s[8:11], s89 offen nt
  buffer_load_dword v17, v4, s[8:11], s65 offen nt
  s_waitcnt vmcnt(1)
  s_memtime s[82:83]
  s_waitcnt vmcnt(0)
  s_memtime s[78:79]
  s_waitcnt lgkmcnt(0)
  s_sub_u32 s100, s78, s82
  s_min_u32 s100, s100, 320
  buffer_load_dword v16, v4, s[12:15], s89 offen nt
  buffer_load_dword v17, v4, s[12:15], s65 offen nt
  s_barrier
  s_waitcnt vmcnt(1)
  s_memtime s[82:83]
  s_waitcnt vmcnt(0)
  s_memtime s[78:79]
  s_waitcnt lgkmcnt(0)
  s_sub_u32 s99, s78, s82
  s_min_u32 s99, s99, 320
  s_xor_b32 s63, s101, s60
  s_xor_b32 s63, s63, s61
  s_and_b32 s63, s63, 1
  s_lshl_b32 s63, s63, 1
  s_sub_u32 s63, 1, s63
  s_mul_i32 s100, s100, s63
  s_mul_i32 s99, s99, s63
  s_bitcmp1_b32 s61, 1
  s_cselect_b32 s63, s99, s100
  s_cselect_b32 s64, s100, s99
  s_lshl_b32 s63, s63, 1
  s_and_b32 s63, s63, 0xfffe
  s_lshl_b32 s64, s64, 16
  s_or_b32 s63, s63, s64
  s_or_b32 s100, s63, s101
  s_mov_b32 s24, s58
  s_mov_b32 s25, s59
  s_mov_b32 s26, 0x40000000
  s_mov_b32 s27, 0x20000
  s_load_dword s75, s[58:59], 0x0
  v_and_b32 v6, 3, v0
  v_lshrrev_b32 v3, 2, v1
  v_lshl_add_u32 v4, v2, 3, v3
  v_lshlrev_b32 v4, 7, v4
  v_lshl_add_u32 v7, v6, 3, v4
  v_lshl_add_u32 v4, v2, 2, v3
  v_lshlrev_b32 v4, 7, v4
  v_lshl_add_u32 v8, v6, 3, v4
  v_mul_u32_u24 v4, 1216, v6
  s_mul_i32 s63, s92, 288
  v_add_u32 v4, s63, v4
  v_lshl_add_u32 v9, v2, 4, v4
  v_lshl_add_u32 v10, v2, 3, v4
  v_lshl_add_u32 v4, v3, 2, v2
  v_lshlrev_b32 v4, 4, v4
  v_lshl_add_u32 v11, v6, 8, v4
  s_lshl_b32 s63, s60, 13
  s_add_u32 s63, s63, 0x280000
  s_lshl_b32 s64, s86, 10
  s_add_u32 s64, s64, 0x280000
  s_waitcnt lgkmcnt(0)
  s_add_u32 s95, s75, 1
  v_mov_b32 v12, s95
  v_mov_b32 v13, s100
  v_and_b32 v14, 31, v0
  v_lshlrev_b32 v14, 3, v14
  v_lshlrev_b32 v15, 4, v0
  s_lshr_b32 s65, s60, 2
  s_lshl_b32 s65, s65, 8
  s_add_u32 s65, s65, 0x10000
  s_and_b32 s66, s2, 31
  s_lshl_b32 s66, s66, 3
  s_add_u32 s66, s66, s65
  s_add_u32 s82, s66, 0x4000
  s_mov_b64 exec, 1
  buffer_store_dwordx2 v[12:13], v14, s[24:27], s82 offen sc1
  s_mov_b64 exec, -1
  v_and_b32 v14, 56, v14
  s_and_b32 s82, s60, 3
  s_lshl_b32 s82, s82, 6
  s_add_u32 s65, s65, s82
  v_mov_b32 v6, 7168
L_wxn:
  ds_read_b32 v5, v6 offset:20
  s_waitcnt lgkmcnt(0)
  v_cmp_gt_u32 vcc, 4, v5
  s_cbranch_vccz L_wxn_done
  s_sub_u32 s76, s76, 1
  s_cmp_le_i32 s76, 0
  s_cbranch_scc1 L_wxn_done
  s_branch L_wxn
L_wxn_done:
  ds_read_b128 v[16:19], v9 offset:0
  ds_read_b128 v[20:23], v9 offset:64
  ds_read_b128 v[24:27], v9 offset:128
  ds_read_b128 v[28:31], v9 offset:192
  ds_read_b64 v[32:33], v10 offset:256
  v_lshlrev_b32 v3, 8, v0
  v_mov_b32 v4, 0
  s_lshl_b32 s82, s60, 10
  s_add_u32 s82, s82, 0x1000
  s_cmp_eq_u32 s61, 0
  s_cselect_b32 s82, s82, 0x40000000
  s_mov_b64 exec, 15
  buffer_store_dword v4, v3, s[24:27], s82 offen offset:128 sc1
  buffer_store_dword v4, v3, s[24:27], s82 offen offset:192 sc1
  buffer_store_dword v4, v3, s[24:27], s82 offen sc1
  s_mov_b64 exec, -1
  ds_read_b64_tr_b16 v[36:37], v7 offset:7424
  ds_read_b64_tr_b16 v[38:39], v7 offset:7936
  ds_read_b64_tr_b16 v[40:41], v7 offset:11520
  ds_read_b64_tr_b16 v[42:43], v7 offset:12032
  ds_read_b64_tr_b16 v[44:45], v7 offset:15616
  ds_read_b64_tr_b16 v[46:47], v7 offset:16128
  ds_read_b64_tr_b16 v[48:49], v7 offset:19712
  ds_read_b64_tr_b16 v[50:51], v7 offset:20224
  ds_read_b64_tr_b16 v[68:69], v8 offset:23808
  s_waitcnt lgkmcnt(5)
  ds_read_b64_tr_b16 v[52:53], v7 offset:7456
  ds_read_b64_tr_b16 v[54:55], v7 offset:7968
  ds_read_b64_tr_b16 v[56:57], v7 offset:11552
  ds_read_b64_tr_b16 v[58:59], v7 offset:12064
  ds_read_b64_tr_b16 v[60:61], v7 offset:15648
  ds_read_b64_tr_b16 v[62:63], v7 offset:16160
  ds_read_b64_tr_b16 v[64:65], v7 offset:19744
  ds_read_b64_tr_b16 v[66:67], v7 offset:20256
  ds_read_b64_tr_b16 v[70:71], v8 offset:23840
  s_waitcnt lgkmcnt(9)
  v_mfma_f32_16x16x32_bf16 v[76:79], v[36:39], v[16:19], 0
  v_mfma_f32_16x16x32_bf16 v[76:79], v[40:43], v[20:23], v[76:79]
  v_mfma_f32_16x16x32_bf16 v[76:79], v[44:47], v[24:27], v[76:79]
  v_mfma_f32_16x16x32_bf16 v[76:79], v[48:51], v[28:31], v[76:79]
  s_waitcnt lgkmcnt(5)
  ds_read_b64_tr_b16 v[36:37], v7 offset:7488
  ds_read_b64_tr_b16 v[38:39], v7 offset:8000
  ds_read_b64_tr_b16 v[40:41], v7 offset:11584
  ds_read_b64_tr_b16 v[42:43], v7 offset:12096
  ds_read_b64_tr_b16 v[44:45], v7 offset:15680
  ds_read_b64_tr_b16 v[46:47], v7 offset:16192
  ds_read_b64_tr_b16 v[48:49], v7 offset:19776
  ds_read_b64_tr_b16 v[50:51], v7 offset:20288
  ds_read_b64_tr_b16 v[72:73], v8 offset:23872
  s_waitcnt lgkmcnt(9)
  v_mfma_f32_16x16x32_bf16 v[80:83], v[52:55], v[16:19], 0
  v_mfma_f32_16x16x32_bf16 v[80:83], v[56:59], v[20:23], v[80:83]
  v_mfma_f32_16x16x32_bf16 v[80:83], v[60:63], v[24:27], v[80:83]
  v_mfma_f32_16x16x32_bf16 v[80:83], v[64:67], v[28:31], v[80:83]
  s_waitcnt lgkmcnt(5)
  ds_read_b64_tr_b16 v[52:53], v7 offset:7520
  ds_read_b64_tr_b16 v[54:55], v7 offset:8032
  ds_read_b64_tr_b16 v[56:57], v7 offset:11616
  ds_read_b64_tr_b16 v[58:59], v7 offset:12128
  ds_read_b64_tr_b16 v[60:61], v7 offset:15712
  ds_read_b64_tr_b16 v[62:63], v7 offset:16224
  ds_read_b64_tr_b16 v[64:65], v7 offset:19808
  ds_read_b64_tr_b16 v[66:67], v7 offset:20320
  ds_read_b64_tr_b16 v[74:75], v8 offset:23904
  s_waitcnt lgkmcnt(9)
  v_mfma_f32_16x16x32_bf16 v[84:87], v[36:39], v[16:19], 0
  v_mfma_f32_16x16x32_bf16 v[84:87], v[40:43], v[20:23], v[84:87]
  v_mfma_f32_16x16x32_bf16 v[84:87], v[44:47], v[24:27], v[84:87]
  v_mfma_f32_16x16x32_bf16 v[84:87], v[48:51], v[28:31], v[84:87]
  s_waitcnt lgkmcnt(0)
  v_mfma_f32_16x16x32_bf16 v[88:91], v[52:55], v[16:19], 0
  v_mfma_f32_16x16x32_bf16 v[88:91], v[56:59], v[20:23], v[88:91]
  v_mfma_f32_16x16x32_bf16 v[88:91], v[60:63], v[24:27], v[88:91]
  v_mfma_f32_16x16x32_bf16 v[88:91], v[64:67], v[28:31], v[88:91]
  s_nop 4
  v_mfma_f32_16x16x16_bf16 v[76:79], v[68:69], v[32:33], v[76:79]
  v_mfma_f32_16x16x16_bf16 v[80:83], v[70:71], v[32:33], v[80:83]
  v_mfma_f32_16x16x16_bf16 v[84:87], v[72:73], v[32:33], v[84:87]
  v_mfma_f32_16x16x16_bf16 v[88:91], v[74:75], v[32:33], v[88:91]
  s_nop 4
  v_mov_b32_dpp v92, v76 quad_perm:[0,1,2,3] row_mask:0xf bank_mask:0x1
  v_mov_b32_dpp v93, v77 quad_perm:[0,1,2,3] row_mask:0xf bank_mask:0x1
  v_mov_b32_dpp v94, v78 quad_perm:[0,1,2,3] row_mask:0xf bank_mask:0x1
  v_mov_b32_dpp v95, v79 quad_perm:[0,1,2,3] row_mask:0xf bank_mask:0x1
  v_mov_b32_dpp v92, v80 quad_perm:[0,1,2,3] row_mask:0xf bank_mask:0x2
  v_mov_b32_dpp v93, v81 quad_perm:[0,1,2,3] row_mask:0xf bank_mask:0x2
  v_mov_b32_dpp v94, v82 quad_perm:[0,1,2,3] row_mask:0xf bank_mask:0x2
  v_mov_b32_dpp v95, v83 quad_perm:[0,1,2,3] row_mask:0xf bank_mask:0x2
  v_mov_b32_dpp v92, v84 quad_perm:[0,1,2,3] row_mask:0xf bank_mask:0x4
  v_mov_b32_dpp v93, v85 quad_perm:[0,1,2,3] row_mask:0xf bank_mask:0x4
  v_mov_b32_dpp v94, v86 quad_perm:[0,1,2,3] row_mask:0xf bank_mask:0x4
  v_mov_b32_dpp v95, v87 quad_perm:[0,1,2,3] row_mask:0xf bank_mask:0x4
  v_mov_b32_dpp v92, v88 quad_perm:[0,1,2,3] row_mask:0xf bank_mask:0x8
  v_mov_b32_dpp v93, v89 quad_perm:[0,1,2,3] row_mask:0xf bank_mask:0x8
  v_mov_b32_dpp v94, v90 quad_perm:[0,1,2,3] row_mask:0xf bank_mask:0x8
  v_mov_b32_dpp v95, v91 quad_perm:[0,1,2,3] row_mask:0xf bank_mask:0x8
  buffer_store_dwordx4 v[92:95], v11, s[24:27], s64 offen sc1
  s_add_u32 s64, s63, 4096
  s_mov_b64 exec, 1
  s_waitcnt vmcnt(0)
  buffer_store_dwordx2 v[12:13], v14, s[24:27], s66 offen sc1
  s_mov_b64 exec, -1
L_pollq:
  buffer_load_dwordx2 v[4:5], v14, s[24:27], s65 offen sc1
  s_waitcnt vmcnt(0)
  v_cmp_ne_u32 vcc, v4, v12
  s_cbranch_vccz L_pollq_done
  s_sub_u32 s76, s76, 1
  s_cmp_le_i32 s76, 0
  s_cbranch_scc1 L_pollq_done
  s_branch L_pollq
L_pollq_done:
  buffer_load_dwordx4 v[36:39], v15, s[24:27], s63 offen offset:0 sc1
  buffer_load_dwordx4 v[40:43], v15, s[24:27], s63 offen offset:1024 sc1
  buffer_load_dwordx4 v[44:47], v15, s[24:27], s63 offen offset:2048 sc1
  buffer_load_dwordx4 v[48:51], v15, s[24:27], s63 offen offset:3072 sc1
  buffer_load_dwordx4 v[52:55], v15, s[24:27], s64 offen offset:0 sc1
  buffer_load_dwordx4 v[56:59], v15, s[24:27], s64 offen offset:1024 sc1
  buffer_load_dwordx4 v[60:63], v15, s[24:27], s64 offen offset:2048 sc1
  buffer_load_dwordx4 v[64:67], v15, s[24:27], s64 offen offset:3072 sc1
  v_lshlrev_b32 v4, 3, v1
  v_lshl_add_u32 v4, v2, 8, v4
  s_waitcnt vmcnt(4)
  v_add_f32 v36, v36, v40
  v_add_f32 v44, v44, v48
  v_add_f32 v36, v36, v44
  v_add_f32 v37, v37, v41
  v_add_f32 v45, v45, v49
  v_add_f32 v37, v37, v45
  v_add_f32 v38, v38, v42
  v_add_f32 v46, v46, v50
  v_add_f32 v38, v38, v46
  v_add_f32 v39, v39, v43
  v_add_f32 v47, v47, v51
  v_add_f32 v39, v39, v47
  v_cvt_pk_bf16_f32 v36, v36, v37
  v_cvt_pk_bf16_f32 v37, v38, v39
  ds_write_b64 v4, v[36:37] offset:4864
  s_waitcnt vmcnt(0)
  v_add_f32 v52, v52, v56
  v_add_f32 v60, v60, v64
  v_add_f32 v52, v52, v60
  v_add_f32 v53, v53, v57
  v_add_f32 v61, v61, v65
  v_add_f32 v53, v53, v61
  v_add_f32 v54, v54, v58
  v_add_f32 v62, v62, v66
  v_add_f32 v54, v54, v62
  v_add_f32 v55, v55, v59
  v_add_f32 v63, v63, v67
  v_add_f32 v55, v55, v63
  v_cvt_pk_bf16_f32 v52, v52, v53
  v_cvt_pk_bf16_f32 v53, v54, v55
  ds_write_b64 v4, v[52:53] offset:4992
  s_waitcnt lgkmcnt(0)
  s_barrier
  s_setprio 0
  v_add_u32 v96, 25856, v7
  v_add_u32 v97, 25856, v8
  s_mul_i32 s63, s87, 9216
  s_mul_i32 s64, s88, 288
  s_add_u32 s63, s63, s64
  s_add_u32 s94, s63, 0x180000
  s_lshl_b32 s96, s86, 11
  s_add_u32 s96, s96, 0x300000
  s_lshl_b32 s97, s93, 11
  s_add_u32 s97, s97, 0x300000
  s_lshl_b32 s98, s86, 5
  s_add_u32 s98, s98, 0x20000
  s_lshl_b32 s99, s93, 5
  s_add_u32 s99, s99, 0x20000
  v_lshrrev_b32 v4, 2, v1
  v_mul_u32_u24 v4, 9216, v4
  v_and_b32 v6, 3, v0
  v_lshl_add_u32 v98, v6, 3, v4
  v_mov_b32 v8, s95
  v_mov_b32 v9, 0
  v_lshrrev_b32 v3, 2, v1
  v_lshlrev_b32 v3, 9, v3
  v_and_b32 v4, 3, v0
  v_lshl_add_u32 v3, v4, 6, v3
  v_lshl_add_u32 v99, v2, 4, v3
  v_lshrrev_b32 v3, 5, v0
  v_lshlrev_b32 v3, 11, v3
  v_and_b32 v4, 31, v0
  v_lshl_add_u32 v13, v4, 4, v3
  v_mov_b32 v6, 7168
L_wgu0:
  ds_read_b32 v5, v6 offset:4
  s_waitcnt lgkmcnt(0)
  v_cmp_gt_u32 vcc, 4, v5
  s_cbranch_vccz L_wgu0_done
  s_sub_u32 s76, s76, 1
  s_cmp_le_i32 s76, 0
  s_cbranch_scc1 L_wgu0_done
  s_sleep 16
  s_branch L_wgu0
L_wgu0_done:
  ds_read_b64_tr_b16 v[36:37], v96 offset:0
  ds_read_b64_tr_b16 v[38:39], v96 offset:512
  ds_read_b64_tr_b16 v[40:41], v96 offset:4096
  ds_read_b64_tr_b16 v[42:43], v96 offset:4608
  ds_read_b64_tr_b16 v[44:45], v96 offset:8192
  ds_read_b64_tr_b16 v[46:47], v96 offset:8704
  ds_read_b64_tr_b16 v[48:49], v96 offset:12288
  ds_read_b64_tr_b16 v[50:51], v96 offset:12800
  ds_read_b64_tr_b16 v[68:69], v97 offset:16384
  s_waitcnt lgkmcnt(5)
  ds_read_b64_tr_b16 v[52:53], v96 offset:32
  ds_read_b64_tr_b16 v[54:55], v96 offset:544
  ds_read_b64_tr_b16 v[56:57], v96 offset:4128
  ds_read_b64_tr_b16 v[58:59], v96 offset:4640
  ds_read_b64_tr_b16 v[60:61], v96 offset:8224
  ds_read_b64_tr_b16 v[62:63], v96 offset:8736
  ds_read_b64_tr_b16 v[64:65], v96 offset:12320
  ds_read_b64_tr_b16 v[66:67], v96 offset:12832
  ds_read_b64_tr_b16 v[70:71], v97 offset:16416
  s_waitcnt lgkmcnt(9)
  v_mfma_f32_16x16x32_bf16 v[76:79], v[36:39], v[16:19], 0
  v_mfma_f32_16x16x32_bf16 v[76:79], v[40:43], v[20:23], v[76:79]
  v_mfma_f32_16x16x32_bf16 v[76:79], v[44:47], v[24:27], v[76:79]
  v_mfma_f32_16x16x32_bf16 v[76:79], v[48:51], v[28:31], v[76:79]
  s_waitcnt lgkmcnt(5)
  ds_read_b64_tr_b16 v[36:37], v96 offset:64
  ds_read_b64_tr_b16 v[38:39], v96 offset:576
  ds_read_b64_tr_b16 v[40:41], v96 offset:4160
  ds_read_b64_tr_b16 v[42:43], v96 offset:4672
  ds_read_b64_tr_b16 v[44:45], v96 offset:8256
  ds_read_b64_tr_b16 v[46:47], v96 offset:8768
  ds_read_b64_tr_b16 v[48:49], v96 offset:12352
  ds_read_b64_tr_b16 v[50:51], v96 offset:12864
  ds_read_b64_tr_b16 v[72:73], v97 offset:16448
  s_waitcnt lgkmcnt(9)
  v_mfma_f32_16x16x32_bf16 v[80:83], v[52:55], v[16:19], 0
  v_mfma_f32_16x16x32_bf16 v[80:83], v[56:59], v[20:23], v[80:83]
  v_mfma_f32_16x16x32_bf16 v[80:83], v[60:63], v[24:27], v[80:83]
  v_mfma_f32_16x16x32_bf16 v[80:83], v[64:67], v[28:31], v[80:83]
  s_waitcnt lgkmcnt(5)
  ds_read_b64_tr_b16 v[52:53], v96 offset:96
  ds_read_b64_tr_b16 v[54:55], v96 offset:608
  ds_read_b64_tr_b16 v[56:57], v96 offset:4192
  ds_read_b64_tr_b16 v[58:59], v96 offset:4704
  ds_read_b64_tr_b16 v[60:61], v96 offset:8288
  ds_read_b64_tr_b16 v[62:63], v96 offset:8800
  ds_read_b64_tr_b16 v[64:65], v96 offset:12384
  ds_read_b64_tr_b16 v[66:67], v96 offset:12896
  ds_read_b64_tr_b16 v[74:75], v97 offset:16480
  s_waitcnt lgkmcnt(9)
  v_mfma_f32_16x16x32_bf16 v[84:87], v[36:39], v[16:19], 0
  v_mfma_f32_16x16x32_bf16 v[84:87], v[40:43], v[20:23], v[84:87]
  v_mfma_f32_16x16x32_bf16 v[84:87], v[44:47], v[24:27], v[84:87]
  v_mfma_f32_16x16x32_bf16 v[84:87], v[48:51], v[28:31], v[84:87]
  s_waitcnt lgkmcnt(0)
  v_mfma_f32_16x16x32_bf16 v[88:91], v[52:55], v[16:19], 0
  v_mfma_f32_16x16x32_bf16 v[88:91], v[56:59], v[20:23], v[88:91]
  v_mfma_f32_16x16x32_bf16 v[88:91], v[60:63], v[24:27], v[88:91]
  v_mfma_f32_16x16x32_bf16 v[88:91], v[64:67], v[28:31], v[88:91]
  s_nop 4
  v_mfma_f32_16x16x16_bf16 v[76:79], v[68:69], v[32:33], v[76:79]
  v_mfma_f32_16x16x16_bf16 v[80:83], v[70:71], v[32:33], v[80:83]
  v_mfma_f32_16x16x16_bf16 v[84:87], v[72:73], v[32:33], v[84:87]
  v_mfma_f32_16x16x16_bf16 v[88:91], v[74:75], v[32:33], v[88:91]
  s_nop 4
  v_mov_b32_dpp v92, v76 quad_perm:[0,1,2,3] row_mask:0xf bank_mask:0x1
  v_mov_b32_dpp v93, v77 quad_perm:[0,1,2,3] row_mask:0xf bank_mask:0x1
  v_mov_b32_dpp v94, v78 quad_perm:[0,1,2,3] row_mask:0xf bank_mask:0x1
  v_mov_b32_dpp v95, v79 quad_perm:[0,1,2,3] row_mask:0xf bank_mask:0x1
  v_mov_b32_dpp v92, v80 quad_perm:[0,1,2,3] row_mask:0xf bank_mask:0x2
  v_mov_b32_dpp v93, v81 quad_perm:[0,1,2,3] row_mask:0xf bank_mask:0x2
  v_mov_b32_dpp v94, v82 quad_perm:[0,1,2,3] row_mask:0xf bank_mask:0x2
  v_mov_b32_dpp v95, v83 quad_perm:[0,1,2,3] row_mask:0xf bank_mask:0x2
  v_mov_b32_dpp v92, v84 quad_perm:[0,1,2,3] row_mask:0xf bank_mask:0x4
  v_mov_b32_dpp v93, v85 quad_perm:[0,1,2,3] row_mask:0xf bank_mask:0x4
  v_mov_b32_dpp v94, v86 quad_perm:[0,1,2,3] row_mask:0xf bank_mask:0x4
  v_mov_b32_dpp v95, v87 quad_perm:[0,1,2,3] row_mask:0xf bank_mask:0x4
  v_mov_b32_dpp v92, v88 quad_perm:[0,1,2,3] row_mask:0xf bank_mask:0x8
  v_mov_b32_dpp v93, v89 quad_perm:[0,1,2,3] row_mask:0xf bank_mask:0x8
  v_mov_b32_dpp v94, v90 quad_perm:[0,1,2,3] row_mask:0xf bank_mask:0x8
  v_mov_b32_dpp v95, v91 quad_perm:[0,1,2,3] row_mask:0xf bank_mask:0x8
  v_mov_b32 v100, v92
  v_mov_b32 v101, v93
  v_mov_b32 v102, v94
  v_mov_b32 v103, v95
  buffer_store_dwordx4 v[100:103], v99, s[24:27], s96 offen offset:0 sc1
  ds_read_b64_tr_b16 v[36:37], v96 offset:18432
  ds_read_b64_tr_b16 v[38:39], v96 offset:18944
  ds_read_b64_tr_b16 v[40:41], v96 offset:22528
  ds_read_b64_tr_b16 v[42:43], v96 offset:23040
  ds_read_b64_tr_b16 v[44:45], v96 offset:26624
  ds_read_b64_tr_b16 v[46:47], v96 offset:27136
  ds_read_b64_tr_b16 v[48:49], v96 offset:30720
  ds_read_b64_tr_b16 v[50:51], v96 offset:31232
  ds_read_b64_tr_b16 v[68:69], v97 offset:34816
  s_waitcnt lgkmcnt(5)
  ds_read_b64_tr_b16 v[52:53], v96 offset:18464
  ds_read_b64_tr_b16 v[54:55], v96 offset:18976
  ds_read_b64_tr_b16 v[56:57], v96 offset:22560
  ds_read_b64_tr_b16 v[58:59], v96 offset:23072
  ds_read_b64_tr_b16 v[60:61], v96 offset:26656
  ds_read_b64_tr_b16 v[62:63], v96 offset:27168
  ds_read_b64_tr_b16 v[64:65], v96 offset:30752
  ds_read_b64_tr_b16 v[66:67], v96 offset:31264
  ds_read_b64_tr_b16 v[70:71], v97 offset:34848
  s_waitcnt lgkmcnt(9)
  v_mfma_f32_16x16x32_bf16 v[76:79], v[36:39], v[16:19], 0
  v_mfma_f32_16x16x32_bf16 v[76:79], v[40:43], v[20:23], v[76:79]
  v_mfma_f32_16x16x32_bf16 v[76:79], v[44:47], v[24:27], v[76:79]
  v_mfma_f32_16x16x32_bf16 v[76:79], v[48:51], v[28:31], v[76:79]
  s_waitcnt lgkmcnt(5)
  ds_read_b64_tr_b16 v[36:37], v96 offset:18496
  ds_read_b64_tr_b16 v[38:39], v96 offset:19008
  ds_read_b64_tr_b16 v[40:41], v96 offset:22592
  ds_read_b64_tr_b16 v[42:43], v96 offset:23104
  ds_read_b64_tr_b16 v[44:45], v96 offset:26688
  ds_read_b64_tr_b16 v[46:47], v96 offset:27200
  ds_read_b64_tr_b16 v[48:49], v96 offset:30784
  ds_read_b64_tr_b16 v[50:51], v96 offset:31296
  ds_read_b64_tr_b16 v[72:73], v97 offset:34880
  s_waitcnt lgkmcnt(9)
  v_mfma_f32_16x16x32_bf16 v[80:83], v[52:55], v[16:19], 0
  v_mfma_f32_16x16x32_bf16 v[80:83], v[56:59], v[20:23], v[80:83]
  v_mfma_f32_16x16x32_bf16 v[80:83], v[60:63], v[24:27], v[80:83]
  v_mfma_f32_16x16x32_bf16 v[80:83], v[64:67], v[28:31], v[80:83]
  s_waitcnt lgkmcnt(5)
  ds_read_b64_tr_b16 v[52:53], v96 offset:18528
  ds_read_b64_tr_b16 v[54:55], v96 offset:19040
  ds_read_b64_tr_b16 v[56:57], v96 offset:22624
  ds_read_b64_tr_b16 v[58:59], v96 offset:23136
  ds_read_b64_tr_b16 v[60:61], v96 offset:26720
  ds_read_b64_tr_b16 v[62:63], v96 offset:27232
  ds_read_b64_tr_b16 v[64:65], v96 offset:30816
  ds_read_b64_tr_b16 v[66:67], v96 offset:31328
  ds_read_b64_tr_b16 v[74:75], v97 offset:34912
  s_waitcnt lgkmcnt(9)
  v_mfma_f32_16x16x32_bf16 v[84:87], v[36:39], v[16:19], 0
  v_mfma_f32_16x16x32_bf16 v[84:87], v[40:43], v[20:23], v[84:87]
  v_mfma_f32_16x16x32_bf16 v[84:87], v[44:47], v[24:27], v[84:87]
  v_mfma_f32_16x16x32_bf16 v[84:87], v[48:51], v[28:31], v[84:87]
  s_waitcnt lgkmcnt(0)
  v_mfma_f32_16x16x32_bf16 v[88:91], v[52:55], v[16:19], 0
  v_mfma_f32_16x16x32_bf16 v[88:91], v[56:59], v[20:23], v[88:91]
  v_mfma_f32_16x16x32_bf16 v[88:91], v[60:63], v[24:27], v[88:91]
  v_mfma_f32_16x16x32_bf16 v[88:91], v[64:67], v[28:31], v[88:91]
  s_nop 4
  v_mfma_f32_16x16x16_bf16 v[76:79], v[68:69], v[32:33], v[76:79]
  v_mfma_f32_16x16x16_bf16 v[80:83], v[70:71], v[32:33], v[80:83]
  v_mfma_f32_16x16x16_bf16 v[84:87], v[72:73], v[32:33], v[84:87]
  v_mfma_f32_16x16x16_bf16 v[88:91], v[74:75], v[32:33], v[88:91]
  s_nop 4
  v_mov_b32_dpp v92, v76 quad_perm:[0,1,2,3] row_mask:0xf bank_mask:0x1
  v_mov_b32_dpp v93, v77 quad_perm:[0,1,2,3] row_mask:0xf bank_mask:0x1
  v_mov_b32_dpp v94, v78 quad_perm:[0,1,2,3] row_mask:0xf bank_mask:0x1
  v_mov_b32_dpp v95, v79 quad_perm:[0,1,2,3] row_mask:0xf bank_mask:0x1
  v_mov_b32_dpp v92, v80 quad_perm:[0,1,2,3] row_mask:0xf bank_mask:0x2
  v_mov_b32_dpp v93, v81 quad_perm:[0,1,2,3] row_mask:0xf bank_mask:0x2
  v_mov_b32_dpp v94, v82 quad_perm:[0,1,2,3] row_mask:0xf bank_mask:0x2
  v_mov_b32_dpp v95, v83 quad_perm:[0,1,2,3] row_mask:0xf bank_mask:0x2
  v_mov_b32_dpp v92, v84 quad_perm:[0,1,2,3] row_mask:0xf bank_mask:0x4
  v_mov_b32_dpp v93, v85 quad_perm:[0,1,2,3] row_mask:0xf bank_mask:0x4
  v_mov_b32_dpp v94, v86 quad_perm:[0,1,2,3] row_mask:0xf bank_mask:0x4
  v_mov_b32_dpp v95, v87 quad_perm:[0,1,2,3] row_mask:0xf bank_mask:0x4
  v_mov_b32_dpp v92, v88 quad_perm:[0,1,2,3] row_mask:0xf bank_mask:0x8
  v_mov_b32_dpp v93, v89 quad_perm:[0,1,2,3] row_mask:0xf bank_mask:0x8
  v_mov_b32_dpp v94, v90 quad_perm:[0,1,2,3] row_mask:0xf bank_mask:0x8
  v_mov_b32_dpp v95, v91 quad_perm:[0,1,2,3] row_mask:0xf bank_mask:0x8
  v_mov_b32 v104, v92
  v_mov_b32 v105, v93
  v_mov_b32 v106, v94
  v_mov_b32 v107, v95
  buffer_store_dwordx4 v[104:107], v99, s[24:27], s96 offen offset:256 sc1
  s_lshl_b32 s63, s86, 4
  s_add_u32 s63, s63, 0x18000
  s_mov_b64 exec, 1
  s_waitcnt vmcnt(0)
  buffer_store_dword v8, v9, s[24:27], s63 offen sc1
  s_mov_b64 exec, -1
  v_mov_b32 v6, 7168
L_wgp0:
  ds_read_b32 v5, v6 offset:12
  s_waitcnt lgkmcnt(0)
  v_cmp_gt_u32 vcc, 4, v5
  s_cbranch_vccz L_wgp0_done
  s_sub_u32 s76, s76, 1
  s_cmp_le_i32 s76, 0
  s_cbranch_scc1 L_wgp0_done
  s_sleep 16
  s_branch L_wgp0
L_wgp0_done:
  s_lshl_b32 s64, s92, 11
  s_sub_u32 s63, s96, s64
  s_lshl_b32 s64, s92, 9
  s_add_u32 s63, s63, s64
  s_add_u32 s64, s63, 4096
  s_andn2_b32 s65, s86, 3
  s_lshl_b32 s65, s65, 4
  s_add_u32 s65, s65, 0x18000
  v_and_b32 v3, 3, v0
  v_lshlrev_b32 v3, 4, v3
L_pollg0:
  buffer_load_dword v5, v3, s[24:27], s65 offen sc1
  s_waitcnt vmcnt(0)
  v_cmp_ne_u32 vcc, v5, v8
  s_cbranch_vccz L_pollg0_done
  s_sub_u32 s76, s76, 1
  s_cmp_le_i32 s76, 0
  s_cbranch_scc1 L_pollg0_done
  s_sleep 32
  s_branch L_pollg0
L_pollg0_done:
  buffer_load_dwordx4 v[36:39], v13, s[24:27], s63 offen sc1
  buffer_load_dwordx4 v[40:43], v13, s[24:27], s64 offen sc1
  s_waitcnt vmcnt(0)
  v_add_f32 v36, v36, v40
  v_add_f32 v37, v37, v41
  v_add_f32 v38, v38, v42
  v_add_f32 v39, v39, v43
  v_mov_b32 v40, v36
  v_mov_b32 v41, v37
  v_mov_b32 v42, v38
  v_mov_b32 v43, v39
  s_nop 1
  v_permlane32_swap_b32 v36, v40
  v_permlane32_swap_b32 v37, v41
  v_permlane32_swap_b32 v38, v42
  v_permlane32_swap_b32 v39, v43
  s_nop 1
  v_add_f32 v36, v36, v40
  v_add_f32 v37, v37, v41
  v_add_f32 v38, v38, v42
  v_add_f32 v39, v39, v43
  v_mov_b32 v40, v36
  v_mov_b32 v41, v37
  v_mov_b32 v42, v38
  v_mov_b32 v43, v39
  s_nop 1
  v_permlane16_swap_b32 v36, v40
  v_permlane16_swap_b32 v37, v41
  v_permlane16_swap_b32 v38, v42
  v_permlane16_swap_b32 v39, v43
  s_nop 1
  v_cvt_pk_bf16_f32 v36, v36, v36
  v_and_b32 v36, s74, v36
  v_cvt_pk_bf16_f32 v40, v40, v40
  v_and_b32 v40, s74, v40
  v_mul_f32 v3, v36, v36
  v_mul_f32 v3, v3, v36
  v_fmamk_f32 v3, v3, 0x3d372713, v36
  v_mul_f32 v3, 0xc0135761, v3
  v_exp_f32 v3, v3
  s_nop 0
  v_add_f32 v3, 1.0, v3
  v_rcp_f32 v3, v3
  s_nop 0
  v_mul_f32 v3, v3, v36
  v_cvt_pk_bf16_f32 v3, v3, v3
  v_and_b32 v3, s74, v3
  v_mul_f32 v36, v3, v40
  v_cvt_pk_bf16_f32 v37, v37, v37
  v_and_b32 v37, s74, v37
  v_cvt_pk_bf16_f32 v41, v41, v41
  v_and_b32 v41, s74, v41
  v_mul_f32 v3, v37, v37
  v_mul_f32 v3, v3, v37
  v_fmamk_f32 v3, v3, 0x3d372713, v37
  v_mul_f32 v3, 0xc0135761, v3
  v_exp_f32 v3, v3
  s_nop 0
  v_add_f32 v3, 1.0, v3
  v_rcp_f32 v3, v3
  s_nop 0
  v_mul_f32 v3, v3, v37
  v_cvt_pk_bf16_f32 v3, v3, v3
  v_and_b32 v3, s74, v3
  v_mul_f32 v37, v3, v41
  v_cvt_pk_bf16_f32 v38, v38, v38
  v_and_b32 v38, s74, v38
  v_cvt_pk_bf16_f32 v42, v42, v42
  v_and_b32 v42, s74, v42
  v_mul_f32 v3, v38, v38
  v_mul_f32 v3, v3, v38
  v_fmamk_f32 v3, v3, 0x3d372713, v38
  v_mul_f32 v3, 0xc0135761, v3
  v_exp_f32 v3, v3
  s_nop 0
  v_add_f32 v3, 1.0, v3
  v_rcp_f32 v3, v3
  s_nop 0
  v_mul_f32 v3, v3, v38
  v_cvt_pk_bf16_f32 v3, v3, v3
  v_and_b32 v3, s74, v3
  v_mul_f32 v38, v3, v42
  v_cvt_pk_bf16_f32 v39, v39, v39
  v_and_b32 v39, s74, v39
  v_cvt_pk_bf16_f32 v43, v43, v43
  v_and_b32 v43, s74, v43
  v_mul_f32 v3, v39, v39
  v_mul_f32 v3, v3, v39
  v_fmamk_f32 v3, v3, 0x3d372713, v39
  v_mul_f32 v3, 0xc0135761, v3
  v_exp_f32 v3, v3
  s_nop 0
  v_add_f32 v3, 1.0, v3
  v_rcp_f32 v3, v3
  s_nop 0
  v_mul_f32 v3, v3, v39
  v_cvt_pk_bf16_f32 v3, v3, v3
  v_and_b32 v3, s74, v3
  v_mul_f32 v39, v3, v43
  v_cvt_pk_bf16_f32 v44, v36, v37
  v_cvt_pk_bf16_f32 v45, v38, v39
  s_mov_b64 exec, 0xffff
  buffer_store_dwordx2 v[44:45], v98, s[24:27], s98 offen sc1
  s_lshl_b32 s63, s86, 2
  s_add_u32 s63, s63, 0x1a000
  s_mov_b64 exec, 1
  s_waitcnt vmcnt(0)
  buffer_store_dword v8, v9, s[24:27], s63 offen sc1
  s_mov_b64 exec, -1
  s_cmp_eq_u32 s77, 0
  s_cbranch_scc1 L_gu2_skip
  v_add_u32 v96, 36864, v96
  v_add_u32 v97, 36864, v97
  v_mov_b32 v6, 7168
L_wgu1:
  ds_read_b32 v5, v6 offset:4
  s_waitcnt lgkmcnt(0)
  v_cmp_gt_u32 vcc, 8, v5
  s_cbranch_vccz L_wgu1_done
  s_sub_u32 s76, s76, 1
  s_cmp_le_i32 s76, 0
  s_cbranch_scc1 L_wgu1_done
  s_sleep 16
  s_branch L_wgu1
L_wgu1_done:
  ds_read_b64_tr_b16 v[36:37], v96 offset:0
  ds_read_b64_tr_b16 v[38:39], v96 offset:512
  ds_read_b64_tr_b16 v[40:41], v96 offset:4096
  ds_read_b64_tr_b16 v[42:43], v96 offset:4608
  ds_read_b64_tr_b16 v[44:45], v96 offset:8192
  ds_read_b64_tr_b16 v[46:47], v96 offset:8704
  ds_read_b64_tr_b16 v[48:49], v96 offset:12288
  ds_read_b64_tr_b16 v[50:51], v96 offset:12800
  ds_read_b64_tr_b16 v[68:69], v97 offset:16384
  s_waitcnt lgkmcnt(5)
  ds_read_b64_tr_b16 v[52:53], v96 offset:32
  ds_read_b64_tr_b16 v[54:55], v96 offset:544
  ds_read_b64_tr_b16 v[56:57], v96 offset:4128
  ds_read_b64_tr_b16 v[58:59], v96 offset:4640
  ds_read_b64_tr_b16 v[60:61], v96 offset:8224
  ds_read_b64_tr_b16 v[62:63], v96 offset:8736
  ds_read_b64_tr_b16 v[64:65], v96 offset:12320
  ds_read_b64_tr_b16 v[66:67], v96 offset:12832
  ds_read_b64_tr_b16 v[70:71], v97 offset:16416
  s_waitcnt lgkmcnt(9)
  v_mfma_f32_16x16x32_bf16 v[76:79], v[36:39], v[16:19], 0
  v_mfma_f32_16x16x32_bf16 v[76:79], v[40:43], v[20:23], v[76:79]
  v_mfma_f32_16x16x32_bf16 v[76:79], v[44:47], v[24:27], v[76:79]
  v_mfma_f32_16x16x32_bf16 v[76:79], v[48:51], v[28:31], v[76:79]
  s_waitcnt lgkmcnt(5)
  ds_read_b64_tr_b16 v[36:37], v96 offset:64
  ds_read_b64_tr_b16 v[38:39], v96 offset:576
  ds_read_b64_tr_b16 v[40:41], v96 offset:4160
  ds_read_b64_tr_b16 v[42:43], v96 offset:4672
  ds_read_b64_tr_b16 v[44:45], v96 offset:8256
  ds_read_b64_tr_b16 v[46:47], v96 offset:8768
  ds_read_b64_tr_b16 v[48:49], v96 offset:12352
  ds_read_b64_tr_b16 v[50:51], v96 offset:12864
  ds_read_b64_tr_b16 v[72:73], v97 offset:16448
  s_waitcnt lgkmcnt(9)
  v_mfma_f32_16x16x32_bf16 v[80:83], v[52:55], v[16:19], 0
  v_mfma_f32_16x16x32_bf16 v[80:83], v[56:59], v[20:23], v[80:83]
  v_mfma_f32_16x16x32_bf16 v[80:83], v[60:63], v[24:27], v[80:83]
  v_mfma_f32_16x16x32_bf16 v[80:83], v[64:67], v[28:31], v[80:83]
  s_waitcnt lgkmcnt(5)
  ds_read_b64_tr_b16 v[52:53], v96 offset:96
  ds_read_b64_tr_b16 v[54:55], v96 offset:608
  ds_read_b64_tr_b16 v[56:57], v96 offset:4192
  ds_read_b64_tr_b16 v[58:59], v96 offset:4704
  ds_read_b64_tr_b16 v[60:61], v96 offset:8288
  ds_read_b64_tr_b16 v[62:63], v96 offset:8800
  ds_read_b64_tr_b16 v[64:65], v96 offset:12384
  ds_read_b64_tr_b16 v[66:67], v96 offset:12896
  ds_read_b64_tr_b16 v[74:75], v97 offset:16480
  s_waitcnt lgkmcnt(9)
  v_mfma_f32_16x16x32_bf16 v[84:87], v[36:39], v[16:19], 0
  v_mfma_f32_16x16x32_bf16 v[84:87], v[40:43], v[20:23], v[84:87]
  v_mfma_f32_16x16x32_bf16 v[84:87], v[44:47], v[24:27], v[84:87]
  v_mfma_f32_16x16x32_bf16 v[84:87], v[48:51], v[28:31], v[84:87]
  s_waitcnt lgkmcnt(0)
  v_mfma_f32_16x16x32_bf16 v[88:91], v[52:55], v[16:19], 0
  v_mfma_f32_16x16x32_bf16 v[88:91], v[56:59], v[20:23], v[88:91]
  v_mfma_f32_16x16x32_bf16 v[88:91], v[60:63], v[24:27], v[88:91]
  v_mfma_f32_16x16x32_bf16 v[88:91], v[64:67], v[28:31], v[88:91]
  s_nop 4
  v_mfma_f32_16x16x16_bf16 v[76:79], v[68:69], v[32:33], v[76:79]
  v_mfma_f32_16x16x16_bf16 v[80:83], v[70:71], v[32:33], v[80:83]
  v_mfma_f32_16x16x16_bf16 v[84:87], v[72:73], v[32:33], v[84:87]
  v_mfma_f32_16x16x16_bf16 v[88:91], v[74:75], v[32:33], v[88:91]
  s_nop 4
  v_mov_b32_dpp v92, v76 quad_perm:[0,1,2,3] row_mask:0xf bank_mask:0x1
  v_mov_b32_dpp v93, v77 quad_perm:[0,1,2,3] row_mask:0xf bank_mask:0x1
  v_mov_b32_dpp v94, v78 quad_perm:[0,1,2,3] row_mask:0xf bank_mask:0x1
  v_mov_b32_dpp v95, v79 quad_perm:[0,1,2,3] row_mask:0xf bank_mask:0x1
  v_mov_b32_dpp v92, v80 quad_perm:[0,1,2,3] row_mask:0xf bank_mask:0x2
  v_mov_b32_dpp v93, v81 quad_perm:[0,1,2,3] row_mask:0xf bank_mask:0x2
  v_mov_b32_dpp v94, v82 quad_perm:[0,1,2,3] row_mask:0xf bank_mask:0x2
  v_mov_b32_dpp v95, v83 quad_perm:[0,1,2,3] row_mask:0xf bank_mask:0x2
  v_mov_b32_dpp v92, v84 quad_perm:[0,1,2,3] row_mask:0xf bank_mask:0x4
  v_mov_b32_dpp v93, v85 quad_perm:[0,1,2,3] row_mask:0xf bank_mask:0x4
  v_mov_b32_dpp v94, v86 quad_perm:[0,1,2,3] row_mask:0xf bank_mask:0x4
  v_mov_b32_dpp v95, v87 quad_perm:[0,1,2,3] row_mask:0xf bank_mask:0x4
  v_mov_b32_dpp v92, v88 quad_perm:[0,1,2,3] row_mask:0xf bank_mask:0x8
  v_mov_b32_dpp v93, v89 quad_perm:[0,1,2,3] row_mask:0xf bank_mask:0x8
  v_mov_b32_dpp v94, v90 quad_perm:[0,1,2,3] row_mask:0xf bank_mask:0x8
  v_mov_b32_dpp v95, v91 quad_perm:[0,1,2,3] row_mask:0xf bank_mask:0x8
  v_mov_b32 v100, v92
  v_mov_b32 v101, v93
  v_mov_b32 v102, v94
  v_mov_b32 v103, v95
  buffer_store_dwordx4 v[100:103], v99, s[24:27], s97 offen offset:0 sc1
  ds_read_b64_tr_b16 v[36:37], v96 offset:18432
  ds_read_b64_tr_b16 v[38:39], v96 offset:18944
  ds_read_b64_tr_b16 v[40:41], v96 offset:22528
  ds_read_b64_tr_b16 v[42:43], v96 offset:23040
  ds_read_b64_tr_b16 v[44:45], v96 offset:26624
  ds_read_b64_tr_b16 v[46:47], v96 offset:27136
  ds_read_b64_tr_b16 v[48:49], v96 offset:30720
  ds_read_b64_tr_b16 v[50:51], v96 offset:31232
  ds_read_b64_tr_b16 v[68:69], v97 offset:34816
  s_waitcnt lgkmcnt(5)
  ds_read_b64_tr_b16 v[52:53], v96 offset:18464
  ds_read_b64_tr_b16 v[54:55], v96 offset:18976
  ds_read_b64_tr_b16 v[56:57], v96 offset:22560
  ds_read_b64_tr_b16 v[58:59], v96 offset:23072
  ds_read_b64_tr_b16 v[60:61], v96 offset:26656
  ds_read_b64_tr_b16 v[62:63], v96 offset:27168
  ds_read_b64_tr_b16 v[64:65], v96 offset:30752
  ds_read_b64_tr_b16 v[66:67], v96 offset:31264
  ds_read_b64_tr_b16 v[70:71], v97 offset:34848
  s_waitcnt lgkmcnt(9)
  v_mfma_f32_16x16x32_bf16 v[76:79], v[36:39], v[16:19], 0
  v_mfma_f32_16x16x32_bf16 v[76:79], v[40:43], v[20:23], v[76:79]
  v_mfma_f32_16x16x32_bf16 v[76:79], v[44:47], v[24:27], v[76:79]
  v_mfma_f32_16x16x32_bf16 v[76:79], v[48:51], v[28:31], v[76:79]
  s_waitcnt lgkmcnt(5)
  ds_read_b64_tr_b16 v[36:37], v96 offset:18496
  ds_read_b64_tr_b16 v[38:39], v96 offset:19008
  ds_read_b64_tr_b16 v[40:41], v96 offset:22592
  ds_read_b64_tr_b16 v[42:43], v96 offset:23104
  ds_read_b64_tr_b16 v[44:45], v96 offset:26688
  ds_read_b64_tr_b16 v[46:47], v96 offset:27200
  ds_read_b64_tr_b16 v[48:49], v96 offset:30784
  ds_read_b64_tr_b16 v[50:51], v96 offset:31296
  ds_read_b64_tr_b16 v[72:73], v97 offset:34880
  s_waitcnt lgkmcnt(9)
  v_mfma_f32_16x16x32_bf16 v[80:83], v[52:55], v[16:19], 0
  v_mfma_f32_16x16x32_bf16 v[80:83], v[56:59], v[20:23], v[80:83]
  v_mfma_f32_16x16x32_bf16 v[80:83], v[60:63], v[24:27], v[80:83]
  v_mfma_f32_16x16x32_bf16 v[80:83], v[64:67], v[28:31], v[80:83]
  s_waitcnt lgkmcnt(5)
  ds_read_b64_tr_b16 v[52:53], v96 offset:18528
  ds_read_b64_tr_b16 v[54:55], v96 offset:19040
  ds_read_b64_tr_b16 v[56:57], v96 offset:22624
  ds_read_b64_tr_b16 v[58:59], v96 offset:23136
  ds_read_b64_tr_b16 v[60:61], v96 offset:26720
  ds_read_b64_tr_b16 v[62:63], v96 offset:27232
  ds_read_b64_tr_b16 v[64:65], v96 offset:30816
  ds_read_b64_tr_b16 v[66:67], v96 offset:31328
  ds_read_b64_tr_b16 v[74:75], v97 offset:34912
  s_waitcnt lgkmcnt(9)
  v_mfma_f32_16x16x32_bf16 v[84:87], v[36:39], v[16:19], 0
  v_mfma_f32_16x16x32_bf16 v[84:87], v[40:43], v[20:23], v[84:87]
  v_mfma_f32_16x16x32_bf16 v[84:87], v[44:47], v[24:27], v[84:87]
  v_mfma_f32_16x16x32_bf16 v[84:87], v[48:51], v[28:31], v[84:87]
  s_waitcnt lgkmcnt(0)
  v_mfma_f32_16x16x32_bf16 v[88:91], v[52:55], v[16:19], 0
  v_mfma_f32_16x16x32_bf16 v[88:91], v[56:59], v[20:23], v[88:91]
  v_mfma_f32_16x16x32_bf16 v[88:91], v[60:63], v[24:27], v[88:91]
  v_mfma_f32_16x16x32_bf16 v[88:91], v[64:67], v[28:31], v[88:91]
  s_nop 4
  v_mfma_f32_16x16x16_bf16 v[76:79], v[68:69], v[32:33], v[76:79]
  v_mfma_f32_16x16x16_bf16 v[80:83], v[70:71], v[32:33], v[80:83]
  v_mfma_f32_16x16x16_bf16 v[84:87], v[72:73], v[32:33], v[84:87]
  v_mfma_f32_16x16x16_bf16 v[88:91], v[74:75], v[32:33], v[88:91]
  s_nop 4
  v_mov_b32_dpp v92, v76 quad_perm:[0,1,2,3] row_mask:0xf bank_mask:0x1
  v_mov_b32_dpp v93, v77 quad_perm:[0,1,2,3] row_mask:0xf bank_mask:0x1
  v_mov_b32_dpp v94, v78 quad_perm:[0,1,2,3] row_mask:0xf bank_mask:0x1
  v_mov_b32_dpp v95, v79 quad_perm:[0,1,2,3] row_mask:0xf bank_mask:0x1
  v_mov_b32_dpp v92, v80 quad_perm:[0,1,2,3] row_mask:0xf bank_mask:0x2
  v_mov_b32_dpp v93, v81 quad_perm:[0,1,2,3] row_mask:0xf bank_mask:0x2
  v_mov_b32_dpp v94, v82 quad_perm:[0,1,2,3] row_mask:0xf bank_mask:0x2
  v_mov_b32_dpp v95, v83 quad_perm:[0,1,2,3] row_mask:0xf bank_mask:0x2
  v_mov_b32_dpp v92, v84 quad_perm:[0,1,2,3] row_mask:0xf bank_mask:0x4
  v_mov_b32_dpp v93, v85 quad_perm:[0,1,2,3] row_mask:0xf bank_mask:0x4
  v_mov_b32_dpp v94, v86 quad_perm:[0,1,2,3] row_mask:0xf bank_mask:0x4
  v_mov_b32_dpp v95, v87 quad_perm:[0,1,2,3] row_mask:0xf bank_mask:0x4
  v_mov_b32_dpp v92, v88 quad_perm:[0,1,2,3] row_mask:0xf bank_mask:0x8
  v_mov_b32_dpp v93, v89 quad_perm:[0,1,2,3] row_mask:0xf bank_mask:0x8
  v_mov_b32_dpp v94, v90 quad_perm:[0,1,2,3] row_mask:0xf bank_mask:0x8
  v_mov_b32_dpp v95, v91 quad_perm:[0,1,2,3] row_mask:0xf bank_mask:0x8
  v_mov_b32 v104, v92
  v_mov_b32 v105, v93
  v_mov_b32 v106, v94
  v_mov_b32 v107, v95
  buffer_store_dwordx4 v[104:107], v99, s[24:27], s97 offen offset:256 sc1
  s_lshl_b32 s63, s93, 4
  s_add_u32 s63, s63, 0x18000
  s_mov_b64 exec, 1
  s_waitcnt vmcnt(0)
  buffer_store_dword v8, v9, s[24:27], s63 offen sc1
  s_mov_b64 exec, -1
  v_mov_b32 v6, 7168
L_wgp1:
  ds_read_b32 v5, v6 offset:12
  s_waitcnt lgkmcnt(0)
  v_cmp_gt_u32 vcc, 8, v5
  s_cbranch_vccz L_wgp1_done
  s_sub_u32 s76, s76, 1
  s_cmp_le_i32 s76, 0
  s_cbranch_scc1 L_wgp1_done
  s_sleep 16
  s_branch L_wgp1
L_wgp1_done:
  s_lshl_b32 s64, s92, 11
  s_sub_u32 s63, s97, s64
  s_lshl_b32 s64, s92, 9
  s_add_u32 s63, s63, s64
  s_add_u32 s64, s63, 4096
  s_andn2_b32 s65, s93, 3
  s_lshl_b32 s65, s65, 4
  s_add_u32 s65, s65, 0x18000
  v_and_b32 v3, 3, v0
  v_lshlrev_b32 v3, 4, v3
L_pollg1:
  buffer_load_dword v5, v3, s[24:27], s65 offen sc1
  s_waitcnt vmcnt(0)
  v_cmp_ne_u32 vcc, v5, v8
  s_cbranch_vccz L_pollg1_done
  s_sub_u32 s76, s76, 1
  s_cmp_le_i32 s76, 0
  s_cbranch_scc1 L_pollg1_done
  s_sleep 32
  s_branch L_pollg1
L_pollg1_done:
  buffer_load_dwordx4 v[36:39], v13, s[24:27], s63 offen sc1
  buffer_load_dwordx4 v[40:43], v13, s[24:27], s64 offen sc1
  s_waitcnt vmcnt(0)
  v_add_f32 v36, v36, v40
  v_add_f32 v37, v37, v41
  v_add_f32 v38, v38, v42
  v_add_f32 v39, v39, v43
  v_mov_b32 v40, v36
  v_mov_b32 v41, v37
  v_mov_b32 v42, v38
  v_mov_b32 v43, v39
  s_nop 1
  v_permlane32_swap_b32 v36, v40
  v_permlane32_swap_b32 v37, v41
  v_permlane32_swap_b32 v38, v42
  v_permlane32_swap_b32 v39, v43
  s_nop 1
  v_add_f32 v36, v36, v40
  v_add_f32 v37, v37, v41
  v_add_f32 v38, v38, v42
  v_add_f32 v39, v39, v43
  v_mov_b32 v40, v36
  v_mov_b32 v41, v37
  v_mov_b32 v42, v38
  v_mov_b32 v43, v39
  s_nop 1
  v_permlane16_swap_b32 v36, v40
  v_permlane16_swap_b32 v37, v41
  v_permlane16_swap_b32 v38, v42
  v_permlane16_swap_b32 v39, v43
  s_nop 1
  v_cvt_pk_bf16_f32 v36, v36, v36
  v_and_b32 v36, s74, v36
  v_cvt_pk_bf16_f32 v40, v40, v40
  v_and_b32 v40, s74, v40
  v_mul_f32 v3, v36, v36
  v_mul_f32 v3, v3, v36
  v_fmamk_f32 v3, v3, 0x3d372713, v36
  v_mul_f32 v3, 0xc0135761, v3
  v_exp_f32 v3, v3
  s_nop 0
  v_add_f32 v3, 1.0, v3
  v_rcp_f32 v3, v3
  s_nop 0
  v_mul_f32 v3, v3, v36
  v_cvt_pk_bf16_f32 v3, v3, v3
  v_and_b32 v3, s74, v3
  v_mul_f32 v36, v3, v40
  v_cvt_pk_bf16_f32 v37, v37, v37
  v_and_b32 v37, s74, v37
  v_cvt_pk_bf16_f32 v41, v41, v41
  v_and_b32 v41, s74, v41
  v_mul_f32 v3, v37, v37
  v_mul_f32 v3, v3, v37
  v_fmamk_f32 v3, v3, 0x3d372713, v37
  v_mul_f32 v3, 0xc0135761, v3
  v_exp_f32 v3, v3
  s_nop 0
  v_add_f32 v3, 1.0, v3
  v_rcp_f32 v3, v3
  s_nop 0
  v_mul_f32 v3, v3, v37
  v_cvt_pk_bf16_f32 v3, v3, v3
  v_and_b32 v3, s74, v3
  v_mul_f32 v37, v3, v41
  v_cvt_pk_bf16_f32 v38, v38, v38
  v_and_b32 v38, s74, v38
  v_cvt_pk_bf16_f32 v42, v42, v42
  v_and_b32 v42, s74, v42
  v_mul_f32 v3, v38, v38
  v_mul_f32 v3, v3, v38
  v_fmamk_f32 v3, v3, 0x3d372713, v38
  v_mul_f32 v3, 0xc0135761, v3
  v_exp_f32 v3, v3
  s_nop 0
  v_add_f32 v3, 1.0, v3
  v_rcp_f32 v3, v3
  s_nop 0
  v_mul_f32 v3, v3, v38
  v_cvt_pk_bf16_f32 v3, v3, v3
  v_and_b32 v3, s74, v3
  v_mul_f32 v38, v3, v42
  v_cvt_pk_bf16_f32 v39, v39, v39
  v_and_b32 v39, s74, v39
  v_cvt_pk_bf16_f32 v43, v43, v43
  v_and_b32 v43, s74, v43
  v_mul_f32 v3, v39, v39
  v_mul_f32 v3, v3, v39
  v_fmamk_f32 v3, v3, 0x3d372713, v39
  v_mul_f32 v3, 0xc0135761, v3
  v_exp_f32 v3, v3
  s_nop 0
  v_add_f32 v3, 1.0, v3
  v_rcp_f32 v3, v3
  s_nop 0
  v_mul_f32 v3, v3, v39
  v_cvt_pk_bf16_f32 v3, v3, v3
  v_and_b32 v3, s74, v3
  v_mul_f32 v39, v3, v43
  v_cvt_pk_bf16_f32 v44, v36, v37
  v_cvt_pk_bf16_f32 v45, v38, v39
  s_mov_b64 exec, 0xffff
  buffer_store_dwordx2 v[44:45], v98, s[24:27], s99 offen sc1
  s_lshl_b32 s63, s93, 2
  s_add_u32 s63, s63, 0x1a000
  s_mov_b64 exec, 1
  s_waitcnt vmcnt(0)
  buffer_store_dword v8, v9, s[24:27], s63 offen sc1
  s_mov_b64 exec, -1
L_gu2_skip:
  v_mov_b32 v6, 7168
L_wlate:
  ds_read_b32 v5, v6 offset:16
  s_waitcnt lgkmcnt(0)
  v_cmp_gt_u32 vcc, 4, v5
  s_cbranch_vccz L_wlate_done
  s_sub_u32 s76, s76, 1
  s_cmp_le_i32 s76, 0
  s_cbranch_scc1 L_wlate_done
  s_sleep 16
  s_branch L_wlate
L_wlate_done:
  s_lshl_b32 s63, s60, 15
  s_lshl_b32 s64, s61, 10
  s_add_u32 s63, s63, s64
  s_add_u32 s63, s63, 0x400000
  v_lshrrev_b32 v3, 3, v0
  v_lshlrev_b32 v3, 13, v3
  v_and_b32 v4, 7, v0
  v_lshl_add_u32 v3, v4, 7, v3
  s_mov_b32 exec_lo, 0x1f1f1f1f
  s_mov_b32 exec_hi, 0
  buffer_load_dword v36, v3, s[24:27], s63 offen sc1
  s_mov_b64 exec, -1
  v_lshrrev_b32 v3, 4, v0
  v_mul_u32_u24 v3, 0x80000, v3
  v_bfe_u32 v4, v0, 2, 2
  v_mul_u32_u24 v4, 2304, v4
  v_and_b32 v5, 3, v0
  v_mul_u32_u24 v5, 92, v5
  v_add3_u32 v3, v3, v4, v5
  s_sub_u32 s63, s94, 0x80000
  s_mov_b32 exec_hi, 0
  buffer_load_dword v37, v3, s[24:27], s63 offen sc1
  s_mov_b64 exec, -1
  s_mul_i32 s65, s87, 36
  s_add_u32 s65, s65, 0x1a000
  v_min_u32 v3, 8, v0
  v_lshlrev_b32 v3, 2, v3
L_pollh:
  buffer_load_dword v5, v3, s[24:27], s65 offen sc1
  s_waitcnt vmcnt(0)
  v_cmp_ne_u32 vcc, v5, v8
  s_cbranch_vccz L_pollh_done
  s_sub_u32 s76, s76, 1
  s_cmp_le_i32 s76, 0
  s_cbranch_scc1 L_pollh_done
  s_sleep 32
  s_branch L_pollh
L_pollh_done:
  v_and_b32 v6, 3, v0
  v_mul_u32_u24 v3, 9216, v6
  v_lshl_add_u32 v4, v2, 3, v3
  v_lshl_add_u32 v3, v2, 4, v3
  s_mul_i32 s63, s87, 288
  s_add_u32 s63, s63, 0x20000
  buffer_load_dwordx4 v[16:19], v3, s[24:27], s63 offen offset:0 sc1
  buffer_load_dwordx4 v[20:23], v3, s[24:27], s63 offen offset:64 sc1
  buffer_load_dwordx4 v[24:27], v3, s[24:27], s63 offen offset:128 sc1
  buffer_load_dwordx4 v[28:31], v3, s[24:27], s63 offen offset:192 sc1
  buffer_load_dwordx2 v[32:33], v4, s[24:27], s63 offen offset:256 sc1
  s_mul_i32 s66, s95, 0x9e3779b1
  s_bfe_u32 s65, s66, 0x80000
  v_mov_b32 v100, s65
  s_bfe_u32 s65, s66, 0x80008
  v_mov_b32 v101, s65
  s_bfe_u32 s65, s66, 0x80010
  v_mov_b32 v102, s65
  s_bfe_u32 s65, s66, 0x80018
  v_mov_b32 v103, s65
  s_mov_b32 s66, 0xffffff00
  s_waitcnt vmcnt(0)
  v_lshrrev_b32 v3, 2, v1
  v_lshl_add_u32 v4, v2, 3, v3
  v_lshl_add_u32 v5, v2, 2, v3
  v_mul_u32_u24 v4, 144, v4
  v_mul_u32_u24 v5, 144, v5
  v_lshl_add_u32 v14, v6, 3, v4
  v_lshl_add_u32 v15, v6, 3, v5
  v_add_u32 v14, 99584, v14
  v_add_u32 v15, 99584, v15
  v_mul_u32_u24 v3, 2304, v1
  v_lshl_add_u32 v12, v2, 4, v3
  s_barrier
  ds_read_b64_tr_b16 v[36:37], v14 offset:0
  ds_read_b64_tr_b16 v[38:39], v14 offset:576
  ds_read_b64_tr_b16 v[40:41], v14 offset:4608
  ds_read_b64_tr_b16 v[42:43], v14 offset:5184
  ds_read_b64_tr_b16 v[44:45], v14 offset:9216
  ds_read_b64_tr_b16 v[46:47], v14 offset:9792
  ds_read_b64_tr_b16 v[48:49], v14 offset:13824
  ds_read_b64_tr_b16 v[50:51], v14 offset:14400
  ds_read_b64_tr_b16 v[68:69], v15 offset:18432
  s_waitcnt lgkmcnt(5)
  ds_read_b64_tr_b16 v[52:53], v14 offset:32
  ds_read_b64_tr_b16 v[54:55], v14 offset:608
  ds_read_b64_tr_b16 v[56:57], v14 offset:4640
  ds_read_b64_tr_b16 v[58:59], v14 offset:5216
  ds_read_b64_tr_b16 v[60:61], v14 offset:9248
  ds_read_b64_tr_b16 v[62:63], v14 offset:9824
  ds_read_b64_tr_b16 v[64:65], v14 offset:13856
  ds_read_b64_tr_b16 v[66:67], v14 offset:14432
  ds_read_b64_tr_b16 v[70:71], v15 offset:18464
  s_waitcnt lgkmcnt(9)
  v_mfma_f32_16x16x32_bf16 v[80:83], v[36:39], v[16:19], 0
  v_mfma_f32_16x16x32_bf16 v[80:83], v[40:43], v[20:23], v[80:83]
  v_mfma_f32_16x16x32_bf16 v[80:83], v[44:47], v[24:27], v[80:83]
  v_mfma_f32_16x16x32_bf16 v[80:83], v[48:51], v[28:31], v[80:83]
  s_waitcnt lgkmcnt(5)
  ds_read_b64_tr_b16 v[36:37], v14 offset:64
  ds_read_b64_tr_b16 v[38:39], v14 offset:640
  ds_read_b64_tr_b16 v[40:41], v14 offset:4672
  ds_read_b64_tr_b16 v[42:43], v14 offset:5248
  ds_read_b64_tr_b16 v[44:45], v14 offset:9280
  ds_read_b64_tr_b16 v[46:47], v14 offset:9856
  ds_read_b64_tr_b16 v[48:49], v14 offset:13888
  ds_read_b64_tr_b16 v[50:51], v14 offset:14464
  ds_read_b64_tr_b16 v[72:73], v15 offset:18496
  s_waitcnt lgkmcnt(9)
  v_mfma_f32_16x16x32_bf16 v[84:87], v[52:55], v[16:19], 0
  v_mfma_f32_16x16x32_bf16 v[84:87], v[56:59], v[20:23], v[84:87]
  v_mfma_f32_16x16x32_bf16 v[84:87], v[60:63], v[24:27], v[84:87]
  v_mfma_f32_16x16x32_bf16 v[84:87], v[64:67], v[28:31], v[84:87]
  s_waitcnt lgkmcnt(5)
  ds_read_b64_tr_b16 v[52:53], v14 offset:96
  ds_read_b64_tr_b16 v[54:55], v14 offset:672
  ds_read_b64_tr_b16 v[56:57], v14 offset:4704
  ds_read_b64_tr_b16 v[58:59], v14 offset:5280
  ds_read_b64_tr_b16 v[60:61], v14 offset:9312
  ds_read_b64_tr_b16 v[62:63], v14 offset:9888
  ds_read_b64_tr_b16 v[64:65], v14 offset:13920
  ds_read_b64_tr_b16 v[66:67], v14 offset:14496
  ds_read_b64_tr_b16 v[74:75], v15 offset:18528
  s_waitcnt lgkmcnt(9)
  v_mfma_f32_16x16x32_bf16 v[88:91], v[36:39], v[16:19], 0
  v_mfma_f32_16x16x32_bf16 v[88:91], v[40:43], v[20:23], v[88:91]
  v_mfma_f32_16x16x32_bf16 v[88:91], v[44:47], v[24:27], v[88:91]
  v_mfma_f32_16x16x32_bf16 v[88:91], v[48:51], v[28:31], v[88:91]
  s_waitcnt lgkmcnt(5)
  ds_read_b64_tr_b16 v[36:37], v14 offset:128
  ds_read_b64_tr_b16 v[38:39], v14 offset:704
  ds_read_b64_tr_b16 v[40:41], v14 offset:4736
  ds_read_b64_tr_b16 v[42:43], v14 offset:5312
  ds_read_b64_tr_b16 v[44:45], v14 offset:9344
  ds_read_b64_tr_b16 v[46:47], v14 offset:9920
  ds_read_b64_tr_b16 v[48:49], v14 offset:13952
  ds_read_b64_tr_b16 v[50:51], v14 offset:14528
  ds_read_b64_tr_b16 v[76:77], v15 offset:18560
  s_waitcnt lgkmcnt(9)
  v_mfma_f32_16x16x32_bf16 v[92:95], v[52:55], v[16:19], 0
  v_mfma_f32_16x16x32_bf16 v[92:95], v[56:59], v[20:23], v[92:95]
  v_mfma_f32_16x16x32_bf16 v[92:95], v[60:63], v[24:27], v[92:95]
  v_mfma_f32_16x16x32_bf16 v[92:95], v[64:67], v[28:31], v[92:95]
  s_waitcnt lgkmcnt(0)
  v_mfma_f32_16x16x32_bf16 v[96:99], v[36:39], v[16:19], 0
  v_mfma_f32_16x16x32_bf16 v[96:99], v[40:43], v[20:23], v[96:99]
  v_mfma_f32_16x16x32_bf16 v[96:99], v[44:47], v[24:27], v[96:99]
  v_mfma_f32_16x16x32_bf16 v[96:99], v[48:51], v[28:31], v[96:99]
  s_nop 3
  v_mfma_f32_16x16x16_bf16 v[80:83], v[68:69], v[32:33], v[80:83]
  v_mfma_f32_16x16x16_bf16 v[84:87], v[70:71], v[32:33], v[84:87]
  v_mfma_f32_16x16x16_bf16 v[88:91], v[72:73], v[32:33], v[88:91]
  v_mfma_f32_16x16x16_bf16 v[92:95], v[74:75], v[32:33], v[92:95]
  v_mfma_f32_16x16x16_bf16 v[96:99], v[76:77], v[32:33], v[96:99]
  s_nop 3
  v_add_u32 v80, 0x80, v80
  v_add_u32 v81, 0x80, v81
  v_add_u32 v82, 0x80, v82
  v_add_u32 v83, 0x80, v83
  v_add_u32 v84, 0x80, v84
  v_add_u32 v85, 0x80, v85
  v_add_u32 v86, 0x80, v86
  v_add_u32 v87, 0x80, v87
  v_add_u32 v88, 0x80, v88
  v_add_u32 v89, 0x80, v89
  v_add_u32 v90, 0x80, v90
  v_add_u32 v91, 0x80, v91
  v_add_u32 v92, 0x80, v92
  v_add_u32 v93, 0x80, v93
  v_add_u32 v94, 0x80, v94
  v_add_u32 v95, 0x80, v95
  v_add_u32 v96, 0x80, v96
  v_add_u32 v97, 0x80, v97
  v_add_u32 v98, 0x80, v98
  v_add_u32 v99, 0x80, v99
  v_and_or_b32 v80, v80, s66, v100
  v_and_or_b32 v81, v81, s66, v101
  v_and_or_b32 v82, v82, s66, v102
  v_and_or_b32 v83, v83, s66, v103
  v_and_or_b32 v84, v84, s66, v100
  v_and_or_b32 v85, v85, s66, v101
  v_and_or_b32 v86, v86, s66, v102
  v_and_or_b32 v87, v87, s66, v103
  v_and_or_b32 v88, v88, s66, v100
  v_and_or_b32 v89, v89, s66, v101
  v_and_or_b32 v90, v90, s66, v102
  v_and_or_b32 v91, v91, s66, v103
  v_and_or_b32 v92, v92, s66, v100
  v_and_or_b32 v93, v93, s66, v101
  v_and_or_b32 v94, v94, s66, v102
  v_and_or_b32 v95, v95, s66, v103
  v_and_or_b32 v96, v96, s66, v100
  v_and_or_b32 v97, v97, s66, v101
  v_and_or_b32 v98, v98, s66, v102
  v_and_or_b32 v99, v99, s66, v103
  s_mov_b64 exec, s[84:85]
  buffer_store_dwordx4 v[80:83], v12, s[24:27], s94 offen offset:0 sc1
  buffer_store_dwordx4 v[84:87], v12, s[24:27], s94 offen offset:64 sc1
  buffer_store_dwordx4 v[88:91], v12, s[24:27], s94 offen offset:128 sc1
  buffer_store_dwordx4 v[92:95], v12, s[24:27], s94 offen offset:192 sc1
  s_mov_b32 exec_hi, 0
  buffer_store_dwordx4 v[96:99], v12, s[24:27], s94 offen offset:256 sc1
  s_barrier
L_hend:
  s_endpgm
L_streamer:
  s_sub_u32 s81, s3, 1
  s_add_u32 s62, s81, s61
  s_and_b32 s62, s62, 3
  v_mul_u32_u24 v15, 24, v0
  s_mul_i32 s63, s62, 1152
  v_lshrrev_b32 v10, 3, v0
  v_lshlrev_b32 v10, 13, v10
  v_and_b32 v11, 7, v0
  v_lshl_add_u32 v9, v11, 4, v10
  v_lshrrev_b32 v10, 2, v1
  v_lshlrev_b32 v10, 8, v10
  v_and_b32 v11, 3, v0
  v_lshl_add_u32 v10, v11, 4, v10
  v_lshl_add_u32 v3, v2, 6, v10
  v_bfe_u32 v10, v0, 2, 1
  v_lshl_add_u32 v3, v10, 15, v3
  v_xor_b32 v186, 0x100, v3
  v_lshlrev_b32 v10, 4, v1
  v_lshl_add_u32 v4, v2, 10, v10
  s_lshl_b32 s68, s62, 26
  s_lshl_b32 s64, s60, 21
  s_add_u32 s68, s68, s64
  s_lshl_b32 s67, s61, 12
  s_add_u32 s67, s67, s68
  s_add_u32 s96, s67, 0x10000
  s_and_b32 s64, s86, 3
  s_mul_i32 s64, s64, 144
  s_mul_i32 s65, s81, 36
  s_add_u32 s64, s64, s65
  s_lshl_b32 s64, s64, 13
  s_lshr_b32 s65, s86, 2
  s_lshl_b32 s65, s65, 7
  s_add_u32 s64, s64, s65
  s_mul_i32 s65, s81, 4608
  s_add_u32 s65, s65, 7424
  s_mov_b32 s82, -1
  s_mov_b32 s83, 0xffff
  s_waitcnt lgkmcnt(0)
  s_mov_b32 s4, s36
  s_mov_b32 s5, s37
  s_mov_b32 s6, 0x1200
  s_mov_b32 s7, 0x20000
  s_load_dword s75, s[58:59], 0x0
  s_mov_b64 exec, s[82:83]
  buffer_load_dwordx2 v[16:17], v15, s[4:7], s63 offen offset:0
  buffer_load_dwordx2 v[18:19], v15, s[4:7], s63 offen offset:8
  buffer_load_dwordx2 v[20:21], v15, s[4:7], s63 offen offset:16
  s_mov_b32 s16, s42
  s_mov_b32 s17, s43
  s_mov_b32 s18, 0x480000
  s_mov_b32 s19, 0x20000
  s_mov_b32 s8, s38
  s_mov_b32 s9, s39
  s_mov_b32 s10, 0x10000000
  s_mov_b32 s11, 0x20000
  s_mov_b32 s12, s40
  s_mov_b32 s13, s41
  s_mov_b32 s14, 0x10000000
  s_mov_b32 s15, 0x20000
  s_mov_b64 exec, 1
  buffer_load_dword v56, v3, s[8:11], s67 offen nt
  buffer_load_dword v57, v3, s[16:19], s64 offen
  s_mov_b64 exec, -1
  s_barrier
  s_add_u32 m0, s65, 0
  s_nop 0
  buffer_load_dwordx4 v9, s[16:19], s64 offen  lds
  s_add_u32 m0, s65, 1024
  s_add_u32 s64, s64, 65536
  buffer_load_dwordx4 v9, s[16:19], s64 offen  lds
  s_add_u32 m0, s65, 2048
  s_add_u32 s64, s64, 65536
  buffer_load_dwordx4 v9, s[16:19], s64 offen  lds
  s_add_u32 m0, s65, 3072
  s_add_u32 s64, s64, 65536
  buffer_load_dwordx4 v9, s[16:19], s64 offen  lds
  s_add_u32 m0, s65, 4096
  s_add_u32 s64, s64, 65536
  s_mov_b32 exec_hi, 0
  buffer_load_dwordx4 v9, s[16:19], s64 offen  lds
  s_mov_b64 exec, -1
  buffer_load_dwordx4 v[56:59], v3, s[8:11], s67 offen offset:0 nt
  buffer_load_dwordx4 v[60:63], v3, s[8:11], s67 offen offset:1024 nt
  buffer_load_dwordx4 v[64:67], v3, s[8:11], s67 offen offset:2048 nt
  buffer_load_dwordx4 v[68:71], v3, s[8:11], s67 offen offset:3072 nt
  buffer_load_dwordx4 v[72:75], v3, s[8:11], s96 offen offset:0 nt
  buffer_load_dwordx4 v[76:79], v3, s[8:11], s96 offen offset:1024 nt
  buffer_load_dwordx4 v[80:83], v3, s[8:11], s96 offen offset:2048 nt
  buffer_load_dwordx4 v[84:87], v3, s[8:11], s96 offen offset:3072 nt
  s_mov_b32 s24, s58
  s_mov_b32 s25, s59
  s_mov_b32 s26, 0x40000000
  s_mov_b32 s27, 0x20000
  s_mov_b32 s16, s48
  s_mov_b32 s17, s49
  s_mov_b32 s18, 0x510000
  s_mov_b32 s19, 0x20000
  s_mov_b32 s20, s50
  s_mov_b32 s21, s51
  s_mov_b32 s22, 0x510000
  s_mov_b32 s23, 0x20000
  s_mov_b32 s28, s52
  s_mov_b32 s29, s53
  s_mov_b32 s30, 0x510000
  s_mov_b32 s31, 0x20000
  s_mov_b32 s32, s44
  s_mov_b32 s33, s45
  s_mov_b32 s34, 0x480000
  s_mov_b32 s35, 0x20000
  v_mov_b32 v36, 0
  s_waitcnt vmcnt(15)
  s_mov_b64 exec, s[82:83]
  v_lshlrev_b32 v24, 16, v16
  v_and_b32 v25, s74, v16
  v_lshlrev_b32 v26, 16, v17
  v_and_b32 v27, s74, v17
  v_lshlrev_b32 v28, 16, v18
  v_and_b32 v29, s74, v18
  v_lshlrev_b32 v30, 16, v19
  v_and_b32 v31, s74, v19
  v_lshlrev_b32 v32, 16, v20
  v_and_b32 v33, s74, v20
  v_lshlrev_b32 v34, 16, v21
  v_and_b32 v35, s74, v21
  v_add_f32 v36, v36, v24
  v_add_f32 v36, v36, v25
  v_add_f32 v36, v36, v26
  v_add_f32 v36, v36, v27
  v_add_f32 v36, v36, v28
  v_add_f32 v36, v36, v29
  v_add_f32 v36, v36, v30
  v_add_f32 v36, v36, v31
  v_add_f32 v36, v36, v32
  v_add_f32 v36, v36, v33
  v_add_f32 v36, v36, v34
  v_add_f32 v36, v36, v35
  s_mov_b64 exec, -1
  s_nop 1
  v_add_f32_dpp v36, v36, v36 row_ror:1 row_mask:0xf bank_mask:0xf
  s_nop 1
  v_add_f32_dpp v36, v36, v36 row_ror:2 row_mask:0xf bank_mask:0xf
  s_nop 1
  v_add_f32_dpp v36, v36, v36 row_ror:4 row_mask:0xf bank_mask:0xf
  s_nop 1
  v_add_f32_dpp v36, v36, v36 row_ror:8 row_mask:0xf bank_mask:0xf
  s_nop 1
  v_mov_b32 v37, v36
  s_nop 1
  v_permlane16_swap_b32 v37, v36
  s_nop 1
  v_add_f32 v36, v36, v37
  s_nop 1
  v_mov_b32 v37, v36
  s_nop 1
  v_permlane32_swap_b32 v37, v36
  s_nop 1
  v_add_f32 v36, v36, v37
  s_nop 1
  v_mul_f32 v38, 0x3ae38e39, v36
  v_mov_b32 v39, 0
  s_mov_b64 exec, s[82:83]
  v_sub_f32 v37, v24, v38
  v_fmac_f32 v39, v37, v37
  v_sub_f32 v37, v25, v38
  v_fmac_f32 v39, v37, v37
  v_sub_f32 v37, v26, v38
  v_fmac_f32 v39, v37, v37
  v_sub_f32 v37, v27, v38
  v_fmac_f32 v39, v37, v37
  v_sub_f32 v37, v28, v38
  v_fmac_f32 v39, v37, v37
  v_sub_f32 v37, v29, v38
  v_fmac_f32 v39, v37, v37
  v_sub_f32 v37, v30, v38
  v_fmac_f32 v39, v37, v37
  v_sub_f32 v37, v31, v38
  v_fmac_f32 v39, v37, v37
  v_sub_f32 v37, v32, v38
  v_fmac_f32 v39, v37, v37
  v_sub_f32 v37, v33, v38
  v_fmac_f32 v39, v37, v37
  v_sub_f32 v37, v34, v38
  v_fmac_f32 v39, v37, v37
  v_sub_f32 v37, v35, v38
  v_fmac_f32 v39, v37, v37
  s_mov_b64 exec, -1
  s_nop 1
  v_add_f32_dpp v39, v39, v39 row_ror:1 row_mask:0xf bank_mask:0xf
  s_nop 1
  v_add_f32_dpp v39, v39, v39 row_ror:2 row_mask:0xf bank_mask:0xf
  s_nop 1
  v_add_f32_dpp v39, v39, v39 row_ror:4 row_mask:0xf bank_mask:0xf
  s_nop 1
  v_add_f32_dpp v39, v39, v39 row_ror:8 row_mask:0xf bank_mask:0xf
  s_nop 1
  v_mov_b32 v37, v39
  s_nop 1
  v_permlane16_swap_b32 v37, v39
  s_nop 1
  v_add_f32 v39, v39, v37
  s_nop 1
  v_mov_b32 v37, v39
  s_nop 1
  v_permlane32_swap_b32 v37, v39
  s_nop 1
  v_add_f32 v39, v39, v37
  s_nop 1
  v_mul_f32 v39, 0x3ae38e39, v39
  v_cvt_pk_bf16_f32 v38, v38, v38
  v_and_b32 v38, s74, v38
  v_cvt_pk_bf16_f32 v39, v39, v39
  v_and_b32 v39, s74, v39
  v_add_f32 v39, 0x3727c5ac, v39
  v_cvt_pk_bf16_f32 v39, v39, v39
  v_and_b32 v39, s74, v39
  v_sqrt_f32 v40, v39
  s_nop 0
  v_rcp_f32 v41, v40
  v_fma_f32 v37, -v40, v40, v39
  v_mul_f32 v41, 0.5, v41
  v_fmac_f32 v40, v37, v41
  v_cvt_pk_bf16_f32 v40, v40, v40
  v_and_b32 v40, s74, v40
  v_rcp_f32 v41, v40
  v_sub_f32 v24, v24, v38
  v_sub_f32 v25, v25, v38
  v_cvt_pk_bf16_f32 v25, v24, v25
  v_lshlrev_b32 v24, 16, v25
  v_and_b32 v25, s74, v25
  v_mul_f32 v37, v24, v41
  v_fma_f32 v24, -v37, v40, v24
  v_fma_f32 v24, v24, v41, v37
  v_mul_f32 v37, v25, v41
  v_fma_f32 v25, -v37, v40, v25
  v_fma_f32 v25, v25, v41, v37
  v_cvt_pk_bf16_f32 v16, v24, v25
  v_sub_f32 v26, v26, v38
  v_sub_f32 v27, v27, v38
  v_cvt_pk_bf16_f32 v27, v26, v27
  v_lshlrev_b32 v26, 16, v27
  v_and_b32 v27, s74, v27
  v_mul_f32 v37, v26, v41
  v_fma_f32 v26, -v37, v40, v26
  v_fma_f32 v26, v26, v41, v37
  v_mul_f32 v37, v27, v41
  v_fma_f32 v27, -v37, v40, v27
  v_fma_f32 v27, v27, v41, v37
  v_cvt_pk_bf16_f32 v17, v26, v27
  v_sub_f32 v28, v28, v38
  v_sub_f32 v29, v29, v38
  v_cvt_pk_bf16_f32 v29, v28, v29
  v_lshlrev_b32 v28, 16, v29
  v_and_b32 v29, s74, v29
  v_mul_f32 v37, v28, v41
  v_fma_f32 v28, -v37, v40, v28
  v_fma_f32 v28, v28, v41, v37
  v_mul_f32 v37, v29, v41
  v_fma_f32 v29, -v37, v40, v29
  v_fma_f32 v29, v29, v41, v37
  v_cvt_pk_bf16_f32 v18, v28, v29
  v_sub_f32 v30, v30, v38
  v_sub_f32 v31, v31, v38
  v_cvt_pk_bf16_f32 v31, v30, v31
  v_lshlrev_b32 v30, 16, v31
  v_and_b32 v31, s74, v31
  v_mul_f32 v37, v30, v41
  v_fma_f32 v30, -v37, v40, v30
  v_fma_f32 v30, v30, v41, v37
  v_mul_f32 v37, v31, v41
  v_fma_f32 v31, -v37, v40, v31
  v_fma_f32 v31, v31, v41, v37
  v_cvt_pk_bf16_f32 v19, v30, v31
  v_sub_f32 v32, v32, v38
  v_sub_f32 v33, v33, v38
  v_cvt_pk_bf16_f32 v33, v32, v33
  v_lshlrev_b32 v32, 16, v33
  v_and_b32 v33, s74, v33
  v_mul_f32 v37, v32, v41
  v_fma_f32 v32, -v37, v40, v32
  v_fma_f32 v32, v32, v41, v37
  v_mul_f32 v37, v33, v41
  v_fma_f32 v33, -v37, v40, v33
  v_fma_f32 v33, v33, v41, v37
  v_cvt_pk_bf16_f32 v20, v32, v33
  v_sub_f32 v34, v34, v38
  v_sub_f32 v35, v35, v38
  v_cvt_pk_bf16_f32 v35, v34, v35
  v_lshlrev_b32 v34, 16, v35
  v_and_b32 v35, s74, v35
  v_mul_f32 v37, v34, v41
  v_fma_f32 v34, -v37, v40, v34
  v_fma_f32 v34, v34, v41, v37
  v_mul_f32 v37, v35, v41
  v_fma_f32 v35, -v37, v40, v35
  v_fma_f32 v35, v35, v41, v37
  v_cvt_pk_bf16_f32 v21, v34, v35
  s_mul_i32 s63, s62, 1216
  v_add_u32 v15, s63, v15
  s_mov_b64 exec, s[82:83]
  ds_write_b64 v15, v[16:17] offset:0
  ds_write_b64 v15, v[18:19] offset:8
  ds_write_b64 v15, v[20:21] offset:16
  s_mov_b64 exec, -1
  s_waitcnt lgkmcnt(0)
  s_waitcnt vmcnt(8)
  v_mov_b32 v11, 7168
  v_mov_b32 v13, 1
  s_mov_b64 exec, 1
  ds_add_u32 v11, v13 offset:20
  s_mov_b64 exec, -1
  v_lshrrev_b32 v10, 3, v0
  v_mul_u32_u24 v10, 9216, v10
  v_and_b32 v11, 7, v0
  v_lshl_add_u32 v15, v11, 4, v10
  s_and_b32 s63, s86, 3
  s_mul_i32 s63, s63, 1327104
  s_lshr_b32 s64, s86, 2
  s_lshl_b32 s64, s64, 7
  s_add_u32 s92, s63, s64
  s_lshr_b32 s64, s60, 2
  s_add_u32 s64, s64, 64
  s_lshl_b32 s64, s64, 7
  s_add_u32 s95, s63, s64
  s_mul_i32 s64, s88, 144
  s_mul_i32 s93, s87, 165888
  s_add_u32 s93, s93, s64
  s_mul_i32 s94, s87, 147456
  s_add_u32 s94, s94, s64
  s_waitcnt vmcnt(7)
  buffer_load_dwordx4 v[88:91], v186, s[8:11], s67 offen offset:0 nt
  s_waitcnt vmcnt(7)
  buffer_load_dwordx4 v[92:95], v186, s[8:11], s67 offen offset:1024 nt
  s_waitcnt vmcnt(7)
  buffer_load_dwordx4 v[96:99], v186, s[8:11], s67 offen offset:2048 nt
  s_waitcnt vmcnt(7)
  buffer_load_dwordx4 v[100:103], v186, s[8:11], s67 offen offset:3072 nt
  s_waitcnt vmcnt(7)
  buffer_load_dwordx4 v[104:107], v186, s[8:11], s96 offen offset:0 nt
  s_waitcnt vmcnt(7)
  buffer_load_dwordx4 v[108:111], v186, s[8:11], s96 offen offset:1024 nt
  s_waitcnt vmcnt(7)
  buffer_load_dwordx4 v[112:115], v186, s[8:11], s96 offen offset:2048 nt
  s_waitcnt vmcnt(7)
  buffer_load_dwordx4 v[116:119], v186, s[8:11], s96 offen offset:3072 nt
  s_add_u32 s63, s81, 0
  s_lshl_b32 s64, s63, 10
  s_add_u32 m0, s64, 25856
  s_mul_i32 s64, s63, 73728
  s_add_u32 s64, s64, s92
  s_waitcnt vmcnt(7)
  buffer_load_dwordx4 v15, s[16:19], s64 offen  lds
  s_add_u32 s63, s81, 0
  s_lshl_b32 s64, s63, 10
  s_add_u32 m0, s64, 44288
  s_mul_i32 s64, s63, 73728
  s_add_u32 s64, s64, s92
  s_waitcnt vmcnt(7)
  buffer_load_dwordx4 v15, s[20:23], s64 offen  lds
  s_add_u32 s63, s81, 4
  s_lshl_b32 s64, s63, 10
  s_add_u32 m0, s64, 25856
  s_mul_i32 s64, s63, 73728
  s_add_u32 s64, s64, s92
  s_waitcnt vmcnt(7)
  buffer_load_dwordx4 v15, s[16:19], s64 offen  lds
  s_add_u32 s63, s81, 4
  s_lshl_b32 s64, s63, 10
  s_add_u32 m0, s64, 44288
  s_mul_i32 s64, s63, 73728
  s_add_u32 s64, s64, s92
  s_waitcnt vmcnt(7)
  buffer_load_dwordx4 v15, s[20:23], s64 offen  lds
  s_add_u32 s63, s81, 8
  s_lshl_b32 s64, s63, 10
  s_add_u32 m0, s64, 25856
  s_mul_i32 s64, s63, 73728
  s_add_u32 s64, s64, s92
  s_waitcnt vmcnt(7)
  buffer_load_dwordx4 v15, s[16:19], s64 offen  lds
  s_add_u32 s63, s81, 8
  s_lshl_b32 s64, s63, 10
  s_add_u32 m0, s64, 44288
  s_mul_i32 s64, s63, 73728
  s_add_u32 s64, s64, s92
  s_waitcnt vmcnt(7)
  buffer_load_dwordx4 v15, s[20:23], s64 offen  lds
  s_add_u32 s63, s81, 12
  s_lshl_b32 s64, s63, 10
  s_add_u32 m0, s64, 25856
  s_mul_i32 s64, s63, 73728
  s_add_u32 s64, s64, s92
  s_waitcnt vmcnt(7)
  buffer_load_dwordx4 v15, s[16:19], s64 offen  lds
  s_add_u32 s63, s81, 12
  s_lshl_b32 s64, s63, 10
  s_add_u32 m0, s64, 44288
  s_mul_i32 s64, s63, 73728
  s_add_u32 s64, s64, s92
  s_waitcnt vmcnt(7)
  buffer_load_dwordx4 v15, s[20:23], s64 offen  lds
  s_add_u32 s63, s81, 16
  s_lshl_b32 s64, s63, 10
  s_add_u32 m0, s64, 25856
  s_mul_i32 s64, s63, 73728
  s_add_u32 s64, s64, s92
  s_cmp_lt_u32 s63, 18
  s_cselect_b32 s64, s64, 0x40000000
  s_cselect_b32 m0, m0, 121088
  s_nop 0
  s_waitcnt vmcnt(7)
  buffer_load_dwordx4 v15, s[16:19], s64 offen  lds
  s_add_u32 s63, s81, 16
  s_lshl_b32 s64, s63, 10
  s_add_u32 m0, s64, 44288
  s_mul_i32 s64, s63, 73728
  s_add_u32 s64, s64, s92
  s_cmp_lt_u32 s63, 18
  s_cselect_b32 s64, s64, 0x40000000
  s_cselect_b32 m0, m0, 121088
  s_nop 0
  s_waitcnt vmcnt(7)
  buffer_load_dwordx4 v15, s[20:23], s64 offen  lds
  s_add_u32 s63, s81, 0
  s_lshl_b32 s64, s63, 10
  s_add_u32 m0, s64, 99584
  s_lshl_b32 s64, s63, 6
  v_add_u32 v11, s64, v0
  v_mul_u32_u24 v13, 7282, v11
  v_lshrrev_b32 v13, 16, v13
  v_lshlrev_b32 v11, 4, v11
  v_mul_u32_u24 v13, 1008, v13
  v_add_u32 v11, v11, v13
  s_mov_b32 s64, s93
  s_waitcnt vmcnt(7)
  buffer_load_dwordx4 v11, s[28:31], s64 offen  lds
  s_add_u32 s63, s81, 4
  s_lshl_b32 s64, s63, 10
  s_add_u32 m0, s64, 99584
  s_lshl_b32 s64, s63, 6
  v_add_u32 v11, s64, v0
  v_mul_u32_u24 v13, 7282, v11
  v_lshrrev_b32 v13, 16, v13
  v_lshlrev_b32 v11, 4, v11
  v_mul_u32_u24 v13, 1008, v13
  v_add_u32 v11, v11, v13
  s_mov_b32 s64, s93
  s_waitcnt vmcnt(7)
  buffer_load_dwordx4 v11, s[28:31], s64 offen  lds
  s_add_u32 s63, s81, 8
  s_lshl_b32 s64, s63, 10
  s_add_u32 m0, s64, 99584
  s_lshl_b32 s64, s63, 6
  v_add_u32 v11, s64, v0
  v_mul_u32_u24 v13, 7282, v11
  v_lshrrev_b32 v13, 16, v13
  v_lshlrev_b32 v11, 4, v11
  v_mul_u32_u24 v13, 1008, v13
  v_add_u32 v11, v11, v13
  s_mov_b32 s64, s93
  s_waitcnt vmcnt(7)
  buffer_load_dwordx4 v11, s[28:31], s64 offen  lds
  s_lshr_b32 s97, s60, 2
  s_lshl_b32 s97, s97, 8
  s_add_u32 s97, s97, 0x14000
  v_and_b32 v24, 31, v0
  v_lshlrev_b32 v24, 3, v24
  s_add_u32 s75, s75, 1
  s_waitcnt vmcnt(7)
  buffer_load_dwordx2 v[26:27], v24, s[24:27], s97 offen sc1
  s_add_u32 s63, s81, 12
  s_lshl_b32 s64, s63, 10
  s_add_u32 m0, s64, 99584
  s_lshl_b32 s64, s63, 6
  v_add_u32 v11, s64, v0
  v_mul_u32_u24 v13, 7282, v11
  v_lshrrev_b32 v13, 16, v13
  v_lshlrev_b32 v11, 4, v11
  v_mul_u32_u24 v13, 1008, v13
  v_add_u32 v11, v11, v13
  s_mov_b32 s64, s93
  s_waitcnt vmcnt(7)
  buffer_load_dwordx4 v11, s[28:31], s64 offen  lds
  s_add_u32 s63, s81, 16
  s_lshl_b32 s64, s63, 10
  s_add_u32 m0, s64, 99584
  s_lshl_b32 s64, s63, 6
  v_add_u32 v11, s64, v0
  v_mul_u32_u24 v13, 7282, v11
  v_lshrrev_b32 v13, 16, v13
  v_lshlrev_b32 v11, 4, v11
  v_mul_u32_u24 v13, 1008, v13
  v_add_u32 v11, v11, v13
  s_mov_b32 s64, s93
  s_waitcnt vmcnt(7)
  buffer_load_dwordx4 v11, s[28:31], s64 offen  lds
  s_add_u32 s63, s81, 20
  s_lshl_b32 s64, s63, 10
  s_add_u32 m0, s64, 99584
  s_lshl_b32 s64, s63, 6
  v_add_u32 v11, s64, v0
  v_mul_u32_u24 v13, 7282, v11
  v_lshrrev_b32 v13, 16, v13
  v_lshlrev_b32 v11, 4, v11
  v_mul_u32_u24 v13, 1008, v13
  v_add_u32 v11, v11, v13
  s_mov_b32 s64, s93
  s_cmp_lt_u32 s63, 21
  s_cselect_b32 s64, s64, 0x40000000
  s_cselect_b32 m0, m0, 121088
  s_nop 0
  s_waitcnt vmcnt(7)
  buffer_load_dwordx4 v11, s[28:31], s64 offen  lds
  s_waitcnt vmcnt(3)
L_vf:
  v_cmp_ne_u32 vcc, s75, v26
  s_cbranch_vccz L_vf_ok
  s_sub_u32 s76, s76, 1
  s_cmp_le_i32 s76, 0
  s_cbranch_scc1 L_vf_ok
  buffer_load_dwordx2 v[26:27], v24, s[24:27], s97 offen sc1
  s_waitcnt vmcnt(0)
  s_branch L_vf
L_vf_ok:
  s_getreg_b32 s99, hwreg(HW_REG_XCC_ID)
  s_lshr_b32 s99, s99, 2
  s_and_b32 s99, s99, 1
  v_and_b32 v24, 1, v27
  v_cmp_ne_u32 vcc, 0, v24
  v_bfe_i32 v25, v27, 1, 15
  v_ashrrev_i32 v27, 16, v27
  s_nop 0
  v_add_u32_dpp v25, v25, v25 row_ror:1 row_mask:0xf bank_mask:0xf
  s_nop 1
  v_add_u32_dpp v25, v25, v25 row_ror:2 row_mask:0xf bank_mask:0xf
  s_nop 1
  v_add_u32_dpp v25, v25, v25 row_ror:4 row_mask:0xf bank_mask:0xf
  s_nop 1
  v_add_u32_dpp v25, v25, v25 row_ror:8 row_mask:0xf bank_mask:0xf
  s_nop 1
  v_mov_b32 v24, v25
  s_nop 1
  v_permlane16_swap_b32 v24, v25
  s_nop 1
  v_add_u32 v25, v25, v24
  s_nop 1
  v_mov_b32 v24, v25
  s_nop 1
  v_permlane32_swap_b32 v24, v25
  s_nop 1
  v_add_u32 v25, v25, v24
  s_nop 1
  v_add_u32_dpp v27, v27, v27 row_ror:1 row_mask:0xf bank_mask:0xf
  s_nop 1
  v_add_u32_dpp v27, v27, v27 row_ror:2 row_mask:0xf bank_mask:0xf
  s_nop 1
  v_add_u32_dpp v27, v27, v27 row_ror:4 row_mask:0xf bank_mask:0xf
  s_nop 1
  v_add_u32_dpp v27, v27, v27 row_ror:8 row_mask:0xf bank_mask:0xf
  s_nop 1
  v_mov_b32 v24, v27
  s_nop 1
  v_permlane16_swap_b32 v24, v27
  s_nop 1
  v_add_u32 v27, v27, v24
  s_nop 1
  v_mov_b32 v24, v27
  s_nop 1
  v_permlane32_swap_b32 v24, v27
  s_nop 1
  v_add_u32 v27, v27, v24
  s_nop 1
  v_readfirstlane_b32 s97, v25
  v_readfirstlane_b32 s98, v27
  s_and_b32 s66, s60, 3
  s_lshl_b32 s66, s66, 3
  s_lshr_b32 s65, vcc_lo, s66
  s_and_b32 s65, s65, 0xff
  s_xor_b32 s66, s65, 0xff
  s_bfm_b32 s82, s61, 0
  s_and_b32 s83, s66, s82
  s_bcnt1_i32_b32 s83, s83
  s_and_b32 s65, s65, s82
  s_bcnt1_i32_b32 s65, s65
  s_bcnt1_i32_b32 s66, s66
  s_add_u32 s65, s65, s66
  s_cmp_eq_u32 s99, 0
  s_cselect_b32 s65, s83, s65
  s_and_b32 s66, s65, 1
  s_and_b32 s82, s65, 2
  s_lshl_b32 s82, s82, 1
  s_or_b32 s66, s66, s82
  s_lshr_b32 s65, s65, 2
  s_xor_b32 s65, s65, s60
  s_mul_i32 s66, s66, 0x11
  s_lshr_b32 s82, s97, 31
  s_xor_b32 s82, s82, s65
  s_and_b32 s82, s82, 1
  s_lshl_b32 s82, s82, 1
  s_or_b32 s66, s66, s82
  s_lshr_b32 s82, s98, 31
  s_xor_b32 s82, s82, s65
  s_and_b32 s82, s82, 1
  s_lshl_b32 s82, s82, 5
  s_or_b32 s66, s66, s82
  s_and_b32 s96, s66, 7
  s_lshr_b32 s101, s66, 4
  s_mov_b32 s99, s96
  s_andn2_b32 s67, s67, 0x7000
  s_lshl_b32 s63, s96, 12
  s_or_b32 s67, s67, s63
  s_add_u32 s67, s67, 0x20000
  s_add_u32 s96, s67, 0x10000
  buffer_load_dwordx4 v[120:123], v3, s[8:11], s67 offen offset:0 nt
  buffer_load_dwordx4 v[124:127], v3, s[8:11], s67 offen offset:1024 nt
  buffer_load_dwordx4 v[128:131], v3, s[8:11], s67 offen offset:2048 nt
  buffer_load_dwordx4 v[132:135], v3, s[8:11], s67 offen offset:3072 nt
  buffer_load_dwordx4 v[136:139], v3, s[8:11], s96 offen offset:0 nt
  s_waitcnt vmcnt(7)
  buffer_load_dwordx4 v[140:143], v3, s[8:11], s96 offen offset:1024 nt
  s_waitcnt vmcnt(7)
  buffer_load_dwordx4 v[144:147], v3, s[8:11], s96 offen offset:2048 nt
  s_waitcnt vmcnt(7)
  buffer_load_dwordx4 v[148:151], v3, s[8:11], s96 offen offset:3072 nt
  s_waitcnt vmcnt(7)
  buffer_load_dwordx4 v[152:155], v186, s[8:11], s67 offen offset:0 nt
  s_waitcnt vmcnt(7)
  buffer_load_dwordx4 v[156:159], v186, s[8:11], s67 offen offset:1024 nt
  s_waitcnt vmcnt(7)
  buffer_load_dwordx4 v[160:163], v186, s[8:11], s67 offen offset:2048 nt
  s_waitcnt vmcnt(7)
  buffer_load_dwordx4 v[164:167], v186, s[8:11], s67 offen offset:3072 nt
  s_waitcnt vmcnt(7)
  buffer_load_dwordx4 v[168:171], v186, s[8:11], s96 offen offset:0 nt
  s_waitcnt vmcnt(7)
  buffer_load_dwordx4 v[172:175], v186, s[8:11], s96 offen offset:1024 nt
  s_waitcnt vmcnt(7)
  buffer_load_dwordx4 v[176:179], v186, s[8:11], s96 offen offset:2048 nt
  s_waitcnt vmcnt(7)
  buffer_load_dwordx4 v[180:183], v186, s[8:11], s96 offen offset:3072 nt
  v_mov_b32 v5, 0xff800000
  v_mov_b32 v6, 0x7f800000
  v_mov_b32 v7, 0
  v_and_b32 v11, 2, v0
  v_cmp_ne_u32 vcc, 0, v11
  v_mov_b32 v12, s74
  v_mov_b32 v11, 0
  v_cndmask_b32 v8, v11, v12, vcc
  v_and_b32 v11, 1, v0
  v_cmp_ne_u32 vcc, 0, v11
  v_mov_b32 v11, 0xffff
  s_nop 0
  v_cndmask_b32 v9, v11, v12, vcc
  v_mov_b32 v20, 0
  v_mov_b32 v21, 0
  v_mov_b32 v22, 0
  v_mov_b32 v23, 0
  v_mov_b32 v24, 0
  v_mov_b32 v25, 0
  v_mov_b32 v26, 0
  v_mov_b32 v27, 0
  v_mov_b32 v28, 0
  v_mov_b32 v29, 0
  v_mov_b32 v30, 0
  v_mov_b32 v31, 0
  v_mov_b32 v32, 0
  v_mov_b32 v33, 0
  v_mov_b32 v34, 0
  v_mov_b32 v35, 0
  v_mov_b32 v36, 0
  v_mov_b32 v37, 0
  v_mov_b32 v38, 0
  v_mov_b32 v39, 0
  v_mov_b32 v40, 0
  v_mov_b32 v41, 0
  v_mov_b32 v42, 0
  v_mov_b32 v43, 0
  v_mov_b32 v44, 0
  v_mov_b32 v45, 0
  v_mov_b32 v46, 0
  v_mov_b32 v47, 0
  v_mov_b32 v48, 0
  v_mov_b32 v49, 0
  v_mov_b32 v50, 0
  v_mov_b32 v51, 0
  v_mov_b32 v52, 0
  v_mov_b32 v53, 0
  v_mov_b32 v54, 0
  v_mov_b32 v55, 0
  v_lshrrev_b32 v187, 2, v0
  v_lshlrev_b32 v187, 3, v187
  s_mul_i32 s63, s81, 2560
  s_add_u32 s63, s63, 122112
  v_add_u32 v188, s63, v187
  s_mov_b32 s90, 0x11111111
  s_mov_b32 s91, 0x11111111
  v_and_b32 v13, 3, v0
  v_lshl_add_u32 v13, v2, 2, v13
  v_lshlrev_b32 v13, 4, v13
  s_lshl_b32 s63, s62, 8
  v_add_u32 v13, s63, v13
  s_lshl_b32 s69, s60, 2
  s_add_u32 s69, s69, s62
  s_lshl_b32 s70, s69, 8
  s_add_u32 s80, s70, 0x500000
  s_add_u32 s70, s70, 0x1000
  s_lshl_b32 s89, s69, 14
  s_add_u32 s89, s89, 0x600000
  s_mov_b32 s69, s99
  s_barrier
  ds_read_b128 v[16:19], v13 offset:4864
  v_mov_b32 v10, 7168
  ds_read_b32 v11, v10 offset:8
  s_waitcnt lgkmcnt(0)
  v_mov_b32_dpp v24, v16 quad_perm:[0,1,2,3] row_mask:0xf bank_mask:0x1
  v_mov_b32_dpp v25, v17 quad_perm:[0,1,2,3] row_mask:0xf bank_mask:0x1
  v_mov_b32_dpp v26, v18 quad_perm:[0,1,2,3] row_mask:0xf bank_mask:0x1
  v_mov_b32_dpp v27, v19 quad_perm:[0,1,2,3] row_mask:0xf bank_mask:0x1
  v_mov_b32_dpp v28, v16 quad_perm:[0,1,2,3] row_mask:0xf bank_mask:0x2
  v_mov_b32_dpp v29, v17 quad_perm:[0,1,2,3] row_mask:0xf bank_mask:0x2
  v_mov_b32_dpp v30, v18 quad_perm:[0,1,2,3] row_mask:0xf bank_mask:0x2
  v_mov_b32_dpp v31, v19 quad_perm:[0,1,2,3] row_mask:0xf bank_mask:0x2
  v_mov_b32_dpp v32, v16 quad_perm:[0,1,2,3] row_mask:0xf bank_mask:0x4
  v_mov_b32_dpp v33, v17 quad_perm:[0,1,2,3] row_mask:0xf bank_mask:0x4
  v_mov_b32_dpp v34, v18 quad_perm:[0,1,2,3] row_mask:0xf bank_mask:0x4
  v_mov_b32_dpp v35, v19 quad_perm:[0,1,2,3] row_mask:0xf bank_mask:0x4
  v_mov_b32_dpp v36, v16 quad_perm:[0,1,2,3] row_mask:0xf bank_mask:0x8
  v_mov_b32_dpp v37, v17 quad_perm:[0,1,2,3] row_mask:0xf bank_mask:0x8
  v_mov_b32_dpp v38, v18 quad_perm:[0,1,2,3] row_mask:0xf bank_mask:0x8
  v_mov_b32_dpp v39, v19 quad_perm:[0,1,2,3] row_mask:0xf bank_mask:0x8
  s_nop 1
  v_mfma_f32_16x16x32_bf16 v[16:19], v[24:27], v[56:59], 0
  v_mfma_f32_16x16x32_bf16 v[16:19], v[28:31], v[60:63], v[16:19]
  v_mfma_f32_16x16x32_bf16 v[16:19], v[32:35], v[64:67], v[16:19]
  v_mfma_f32_16x16x32_bf16 v[16:19], v[36:39], v[68:71], v[16:19]
  s_add_u32 s67, s67, 0x20000
  s_add_u32 s96, s67, 0x10000
  buffer_load_dwordx4 v[56:59], v3, s[8:11], s67 offen offset:0 nt
  buffer_load_dwordx4 v[60:63], v3, s[8:11], s67 offen offset:1024 nt
  buffer_load_dwordx4 v[64:67], v3, s[8:11], s67 offen offset:2048 nt
  buffer_load_dwordx4 v[68:71], v3, s[8:11], s67 offen offset:3072 nt
  v_mov_b32 v11, 7168
  v_mov_b32 v13, 1
  s_mov_b64 exec, 1
  ds_add_u32 v11, v13 offset:4
  s_mov_b64 exec, -1
  s_add_u32 s63, s81, 0
  s_lshl_b32 s64, s63, 10
  s_add_u32 m0, s64, 7424
  s_lshl_b32 s64, s63, 6
  v_add_u32 v11, s64, v0
  v_mul_u32_u24 v13, 7282, v11
  v_lshrrev_b32 v13, 16, v13
  v_lshlrev_b32 v11, 4, v11
  v_mul_u32_u24 v13, 1008, v13
  v_add_u32 v11, v11, v13
  s_mov_b32 s64, s94
  buffer_load_dwordx4 v11, s[32:35], s64 offen  lds
  v_mov_b32_dpp v10, v16 quad_perm:[0,0,0,0] row_mask:0xf bank_mask:0xf
  v_add_f32_dpp v10, v17, v10 quad_perm:[1,1,1,1] row_mask:0xf bank_mask:0xf
  v_add_f32_dpp v10, v18, v10 quad_perm:[2,2,2,2] row_mask:0xf bank_mask:0xf
  v_add_f32_dpp v10, v19, v10 quad_perm:[3,3,3,3] row_mask:0xf bank_mask:0xf
  v_cvt_pk_bf16_f32 v10, v10, v10
  v_and_b32 v10, s74, v10
  v_mul_f32 v10, s72, v10
  v_cvt_pk_bf16_f32 v184, v10, v10
  v_mfma_f32_16x16x32_bf16 v[16:19], v[24:27], v[72:75], 0
  v_mfma_f32_16x16x32_bf16 v[16:19], v[28:31], v[76:79], v[16:19]
  v_mfma_f32_16x16x32_bf16 v[16:19], v[32:35], v[80:83], v[16:19]
  v_mfma_f32_16x16x32_bf16 v[16:19], v[36:39], v[84:87], v[16:19]
  buffer_load_dwordx4 v[72:75], v3, s[8:11], s96 offen offset:0 nt
  buffer_load_dwordx4 v[76:79], v3, s[8:11], s96 offen offset:1024 nt
  buffer_load_dwordx4 v[80:83], v3, s[8:11], s96 offen offset:2048 nt
  buffer_load_dwordx4 v[84:87], v3, s[8:11], s96 offen offset:3072 nt
  s_add_u32 s63, s81, 4
  s_lshl_b32 s64, s63, 10
  s_add_u32 m0, s64, 7424
  s_lshl_b32 s64, s63, 6
  v_add_u32 v11, s64, v0
  v_mul_u32_u24 v13, 7282, v11
  v_lshrrev_b32 v13, 16, v13
  v_lshlrev_b32 v11, 4, v11
  v_mul_u32_u24 v13, 1008, v13
  v_add_u32 v11, v11, v13
  s_mov_b32 s64, s94
  buffer_load_dwordx4 v11, s[32:35], s64 offen  lds
  v_mov_b32_dpp v10, v16 quad_perm:[0,0,0,0] row_mask:0xf bank_mask:0xf
  v_add_f32_dpp v10, v17, v10 quad_perm:[1,1,1,1] row_mask:0xf bank_mask:0xf
  v_add_f32_dpp v10, v18, v10 quad_perm:[2,2,2,2] row_mask:0xf bank_mask:0xf
  v_add_f32_dpp v10, v19, v10 quad_perm:[3,3,3,3] row_mask:0xf bank_mask:0xf
  v_cvt_pk_bf16_f32 v10, v10, v10
  v_and_b32 v10, s74, v10
  v_mul_f32 v10, s72, v10
  v_cvt_pk_bf16_f32 v10, v10, v10
  v_bfi_b32 v184, s74, v10, v184
  v_mfma_f32_16x16x32_bf16 v[16:19], v[24:27], v[88:91], 0
  v_mfma_f32_16x16x32_bf16 v[16:19], v[28:31], v[92:95], v[16:19]
  v_mfma_f32_16x16x32_bf16 v[16:19], v[32:35], v[96:99], v[16:19]
  v_mfma_f32_16x16x32_bf16 v[16:19], v[36:39], v[100:103], v[16:19]
  buffer_load_dwordx4 v[88:91], v186, s[8:11], s67 offen offset:0 nt
  buffer_load_dwordx4 v[92:95], v186, s[8:11], s67 offen offset:1024 nt
  buffer_load_dwordx4 v[96:99], v186, s[8:11], s67 offen offset:2048 nt
  buffer_load_dwordx4 v[100:103], v186, s[8:11], s67 offen offset:3072 nt
  s_add_u32 s63, s81, 8
  s_lshl_b32 s64, s63, 10
  s_add_u32 m0, s64, 7424
  s_lshl_b32 s64, s63, 6
  v_add_u32 v11, s64, v0
  v_mul_u32_u24 v13, 7282, v11
  v_lshrrev_b32 v13, 16, v13
  v_lshlrev_b32 v11, 4, v11
  v_mul_u32_u24 v13, 1008, v13
  v_add_u32 v11, v11, v13
  s_mov_b32 s64, s94
  buffer_load_dwordx4 v11, s[32:35], s64 offen  lds
  v_mov_b32_dpp v10, v16 quad_perm:[0,0,0,0] row_mask:0xf bank_mask:0xf
  v_add_f32_dpp v10, v17, v10 quad_perm:[1,1,1,1] row_mask:0xf bank_mask:0xf
  v_add_f32_dpp v10, v18, v10 quad_perm:[2,2,2,2] row_mask:0xf bank_mask:0xf
  v_add_f32_dpp v10, v19, v10 quad_perm:[3,3,3,3] row_mask:0xf bank_mask:0xf
  v_cvt_pk_bf16_f32 v10, v10, v10
  v_and_b32 v10, s74, v10
  v_mul_f32 v10, s72, v10
  v_cvt_pk_bf16_f32 v185, v10, v10
  v_mfma_f32_16x16x32_bf16 v[16:19], v[24:27], v[104:107], 0
  v_mfma_f32_16x16x32_bf16 v[16:19], v[28:31], v[108:111], v[16:19]
  v_mfma_f32_16x16x32_bf16 v[16:19], v[32:35], v[112:115], v[16:19]
  v_mfma_f32_16x16x32_bf16 v[16:19], v[36:39], v[116:119], v[16:19]
  buffer_load_dwordx4 v[104:107], v186, s[8:11], s96 offen offset:0 nt
  buffer_load_dwordx4 v[108:111], v186, s[8:11], s96 offen offset:1024 nt
  buffer_load_dwordx4 v[112:115], v186, s[8:11], s96 offen offset:2048 nt
  buffer_load_dwordx4 v[116:119], v186, s[8:11], s96 offen offset:3072 nt
  s_add_u32 s63, s81, 12
  s_lshl_b32 s64, s63, 10
  s_add_u32 m0, s64, 7424
  s_lshl_b32 s64, s63, 6
  v_add_u32 v11, s64, v0
  v_mul_u32_u24 v13, 7282, v11
  v_lshrrev_b32 v13, 16, v13
  v_lshlrev_b32 v11, 4, v11
  v_mul_u32_u24 v13, 1008, v13
  v_add_u32 v11, v11, v13
  s_mov_b32 s64, s94
  buffer_load_dwordx4 v11, s[32:35], s64 offen  lds
  v_mov_b32_dpp v10, v16 quad_perm:[0,0,0,0] row_mask:0xf bank_mask:0xf
  v_add_f32_dpp v10, v17, v10 quad_perm:[1,1,1,1] row_mask:0xf bank_mask:0xf
  v_add_f32_dpp v10, v18, v10 quad_perm:[2,2,2,2] row_mask:0xf bank_mask:0xf
  v_add_f32_dpp v10, v19, v10 quad_perm:[3,3,3,3] row_mask:0xf bank_mask:0xf
  v_cvt_pk_bf16_f32 v10, v10, v10
  v_and_b32 v10, s74, v10
  v_mul_f32 v10, s72, v10
  v_cvt_pk_bf16_f32 v10, v10, v10
  v_bfi_b32 v185, s74, v10, v185
  s_mov_b64 exec, s[90:91]
  ds_write_b64 v188, v[184:185]
  s_mov_b64 exec, -1
  v_add_u32 v188, 128, v188
  v_mfma_f32_16x16x32_bf16 v[16:19], v[24:27], v[120:123], 0
  v_mfma_f32_16x16x32_bf16 v[16:19], v[28:31], v[124:127], v[16:19]
  v_mfma_f32_16x16x32_bf16 v[16:19], v[32:35], v[128:131], v[16:19]
  v_mfma_f32_16x16x32_bf16 v[16:19], v[36:39], v[132:135], v[16:19]
  s_add_u32 s67, s67, 0x20000
  s_add_u32 s96, s67, 0x10000
  buffer_load_dwordx4 v[120:123], v3, s[8:11], s67 offen offset:0 nt
  buffer_load_dwordx4 v[124:127], v3, s[8:11], s67 offen offset:1024 nt
  buffer_load_dwordx4 v[128:131], v3, s[8:11], s67 offen offset:2048 nt
  buffer_load_dwordx4 v[132:135], v3, s[8:11], s67 offen offset:3072 nt
  s_add_u32 s63, s81, 16
  s_lshl_b32 s64, s63, 10
  s_add_u32 m0, s64, 7424
  s_lshl_b32 s64, s63, 6
  v_add_u32 v11, s64, v0
  v_mul_u32_u24 v13, 7282, v11
  v_lshrrev_b32 v13, 16, v13
  v_lshlrev_b32 v11, 4, v11
  v_mul_u32_u24 v13, 1008, v13
  v_add_u32 v11, v11, v13
  s_mov_b32 s64, s94
  s_cmp_lt_u32 s63, 18
  s_cselect_b32 s64, s64, 0x40000000
  s_cselect_b32 m0, m0, 121088
  s_nop 0
  buffer_load_dwordx4 v11, s[32:35], s64 offen  lds
  v_mov_b32_dpp v10, v16 quad_perm:[0,0,0,0] row_mask:0xf bank_mask:0xf
  v_add_f32_dpp v10, v17, v10 quad_perm:[1,1,1,1] row_mask:0xf bank_mask:0xf
  v_add_f32_dpp v10, v18, v10 quad_perm:[2,2,2,2] row_mask:0xf bank_mask:0xf
  v_add_f32_dpp v10, v19, v10 quad_perm:[3,3,3,3] row_mask:0xf bank_mask:0xf
  v_cvt_pk_bf16_f32 v10, v10, v10
  v_and_b32 v10, s74, v10
  v_mul_f32 v10, s72, v10
  v_cvt_pk_bf16_f32 v184, v10, v10
  v_mfma_f32_16x16x32_bf16 v[16:19], v[24:27], v[136:139], 0
  v_mfma_f32_16x16x32_bf16 v[16:19], v[28:31], v[140:143], v[16:19]
  v_mfma_f32_16x16x32_bf16 v[16:19], v[32:35], v[144:147], v[16:19]
  v_mfma_f32_16x16x32_bf16 v[16:19], v[36:39], v[148:151], v[16:19]
  buffer_load_dwordx4 v[136:139], v3, s[8:11], s96 offen offset:0 nt
  buffer_load_dwordx4 v[140:143], v3, s[8:11], s96 offen offset:1024 nt
  buffer_load_dwordx4 v[144:147], v3, s[8:11], s96 offen offset:2048 nt
  buffer_load_dwordx4 v[148:151], v3, s[8:11], s96 offen offset:3072 nt
  s_nop 3
  v_mov_b32_dpp v10, v16 quad_perm:[0,0,0,0] row_mask:0xf bank_mask:0xf
  v_add_f32_dpp v10, v17, v10 quad_perm:[1,1,1,1] row_mask:0xf bank_mask:0xf
  v_add_f32_dpp v10, v18, v10 quad_perm:[2,2,2,2] row_mask:0xf bank_mask:0xf
  v_add_f32_dpp v10, v19, v10 quad_perm:[3,3,3,3] row_mask:0xf bank_mask:0xf
  v_cvt_pk_bf16_f32 v10, v10, v10
  v_and_b32 v10, s74, v10
  v_mul_f32 v10, s72, v10
  v_cvt_pk_bf16_f32 v10, v10, v10
  v_bfi_b32 v184, s74, v10, v184
  s_waitcnt vmcnt(33)
  v_mfma_f32_16x16x32_bf16 v[16:19], v[24:27], v[152:155], 0
  v_mfma_f32_16x16x32_bf16 v[16:19], v[28:31], v[156:159], v[16:19]
  v_mfma_f32_16x16x32_bf16 v[16:19], v[32:35], v[160:163], v[16:19]
  v_mfma_f32_16x16x32_bf16 v[16:19], v[36:39], v[164:167], v[16:19]
  buffer_load_dwordx4 v[152:155], v186, s[8:11], s67 offen offset:0 nt
  buffer_load_dwordx4 v[156:159], v186, s[8:11], s67 offen offset:1024 nt
  buffer_load_dwordx4 v[160:163], v186, s[8:11], s67 offen offset:2048 nt
  buffer_load_dwordx4 v[164:167], v186, s[8:11], s67 offen offset:3072 nt
  s_nop 3
  v_mov_b32_dpp v10, v16 quad_perm:[0,0,0,0] row_mask:0xf bank_mask:0xf
  v_add_f32_dpp v10, v17, v10 quad_perm:[1,1,1,1] row_mask:0xf bank_mask:0xf
  v_add_f32_dpp v10, v18, v10 quad_perm:[2,2,2,2] row_mask:0xf bank_mask:0xf
  v_add_f32_dpp v10, v19, v10 quad_perm:[3,3,3,3] row_mask:0xf bank_mask:0xf
  v_cvt_pk_bf16_f32 v10, v10, v10
  v_and_b32 v10, s74, v10
  v_mul_f32 v10, s72, v10
  v_cvt_pk_bf16_f32 v185, v10, v10
  s_waitcnt vmcnt(33)
  v_mfma_f32_16x16x32_bf16 v[16:19], v[24:27], v[168:171], 0
  v_mfma_f32_16x16x32_bf16 v[16:19], v[28:31], v[172:175], v[16:19]
  v_mfma_f32_16x16x32_bf16 v[16:19], v[32:35], v[176:179], v[16:19]
  v_mfma_f32_16x16x32_bf16 v[16:19], v[36:39], v[180:183], v[16:19]
  buffer_load_dwordx4 v[168:171], v186, s[8:11], s96 offen offset:0 nt
  buffer_load_dwordx4 v[172:175], v186, s[8:11], s96 offen offset:1024 nt
  buffer_load_dwordx4 v[176:179], v186, s[8:11], s96 offen offset:2048 nt
  buffer_load_dwordx4 v[180:183], v186, s[8:11], s96 offen offset:3072 nt
  s_nop 3
  v_mov_b32_dpp v10, v16 quad_perm:[0,0,0,0] row_mask:0xf bank_mask:0xf
  v_add_f32_dpp v10, v17, v10 quad_perm:[1,1,1,1] row_mask:0xf bank_mask:0xf
  v_add_f32_dpp v10, v18, v10 quad_perm:[2,2,2,2] row_mask:0xf bank_mask:0xf
  v_add_f32_dpp v10, v19, v10 quad_perm:[3,3,3,3] row_mask:0xf bank_mask:0xf
  v_cvt_pk_bf16_f32 v10, v10, v10
  v_and_b32 v10, s74, v10
  v_mul_f32 v10, s72, v10
  v_cvt_pk_bf16_f32 v10, v10, v10
  v_bfi_b32 v185, s74, v10, v185
  s_mov_b64 exec, s[90:91]
  ds_write_b64 v188, v[184:185]
  s_mov_b64 exec, -1
  v_add_u32 v188, 128, v188
  s_waitcnt vmcnt(33)
  v_mfma_f32_16x16x32_bf16 v[16:19], v[24:27], v[56:59], 0
  v_mfma_f32_16x16x32_bf16 v[16:19], v[28:31], v[60:63], v[16:19]
  v_mfma_f32_16x16x32_bf16 v[16:19], v[32:35], v[64:67], v[16:19]
  v_mfma_f32_16x16x32_bf16 v[16:19], v[36:39], v[68:71], v[16:19]
  s_nop 7
  v_mov_b32_dpp v10, v16 quad_perm:[0,0,0,0] row_mask:0xf bank_mask:0xf
  v_add_f32_dpp v10, v17, v10 quad_perm:[1,1,1,1] row_mask:0xf bank_mask:0xf
  v_add_f32_dpp v10, v18, v10 quad_perm:[2,2,2,2] row_mask:0xf bank_mask:0xf
  v_add_f32_dpp v10, v19, v10 quad_perm:[3,3,3,3] row_mask:0xf bank_mask:0xf
  v_cvt_pk_bf16_f32 v10, v10, v10
  v_and_b32 v10, s74, v10
  v_mul_f32 v10, s72, v10
  v_cvt_pk_bf16_f32 v184, v10, v10
  s_waitcnt vmcnt(28)
  v_mfma_f32_16x16x32_bf16 v[16:19], v[24:27], v[72:75], 0
  v_mfma_f32_16x16x32_bf16 v[16:19], v[28:31], v[76:79], v[16:19]
  v_mfma_f32_16x16x32_bf16 v[16:19], v[32:35], v[80:83], v[16:19]
  v_mfma_f32_16x16x32_bf16 v[16:19], v[36:39], v[84:87], v[16:19]
  s_nop 7
  v_mov_b32_dpp v10, v16 quad_perm:[0,0,0,0] row_mask:0xf bank_mask:0xf
  v_add_f32_dpp v10, v17, v10 quad_perm:[1,1,1,1] row_mask:0xf bank_mask:0xf
  v_add_f32_dpp v10, v18, v10 quad_perm:[2,2,2,2] row_mask:0xf bank_mask:0xf
  v_add_f32_dpp v10, v19, v10 quad_perm:[3,3,3,3] row_mask:0xf bank_mask:0xf
  v_cvt_pk_bf16_f32 v10, v10, v10
  v_and_b32 v10, s74, v10
  v_mul_f32 v10, s72, v10
  v_cvt_pk_bf16_f32 v10, v10, v10
  v_bfi_b32 v184, s74, v10, v184
  s_waitcnt vmcnt(23)
  v_mfma_f32_16x16x32_bf16 v[16:19], v[24:27], v[88:91], 0
  v_mfma_f32_16x16x32_bf16 v[16:19], v[28:31], v[92:95], v[16:19]
  v_mfma_f32_16x16x32_bf16 v[16:19], v[32:35], v[96:99], v[16:19]
  v_mfma_f32_16x16x32_bf16 v[16:19], v[36:39], v[100:103], v[16:19]
  s_nop 7
  v_mov_b32_dpp v10, v16 quad_perm:[0,0,0,0] row_mask:0xf bank_mask:0xf
  v_add_f32_dpp v10, v17, v10 quad_perm:[1,1,1,1] row_mask:0xf bank_mask:0xf
  v_add_f32_dpp v10, v18, v10 quad_perm:[2,2,2,2] row_mask:0xf bank_mask:0xf
  v_add_f32_dpp v10, v19, v10 quad_perm:[3,3,3,3] row_mask:0xf bank_mask:0xf
  v_cvt_pk_bf16_f32 v10, v10, v10
  v_and_b32 v10, s74, v10
  v_mul_f32 v10, s72, v10
  v_cvt_pk_bf16_f32 v185, v10, v10
  s_waitcnt vmcnt(18)
  v_mfma_f32_16x16x32_bf16 v[16:19], v[24:27], v[104:107], 0
  v_mfma_f32_16x16x32_bf16 v[16:19], v[28:31], v[108:111], v[16:19]
  v_mfma_f32_16x16x32_bf16 v[16:19], v[32:35], v[112:115], v[16:19]
  v_mfma_f32_16x16x32_bf16 v[16:19], v[36:39], v[116:119], v[16:19]
  s_nop 7
  v_mov_b32_dpp v10, v16 quad_perm:[0,0,0,0] row_mask:0xf bank_mask:0xf
  v_add_f32_dpp v10, v17, v10 quad_perm:[1,1,1,1] row_mask:0xf bank_mask:0xf
  v_add_f32_dpp v10, v18, v10 quad_perm:[2,2,2,2] row_mask:0xf bank_mask:0xf
  v_add_f32_dpp v10, v19, v10 quad_perm:[3,3,3,3] row_mask:0xf bank_mask:0xf
  v_cvt_pk_bf16_f32 v10, v10, v10
  v_and_b32 v10, s74, v10
  v_mul_f32 v10, s72, v10
  v_cvt_pk_bf16_f32 v10, v10, v10
  v_bfi_b32 v185, s74, v10, v185
  s_mov_b64 exec, s[90:91]
  ds_write_b64 v188, v[184:185]
  s_mov_b64 exec, -1
  v_add_u32 v188, 128, v188
  s_waitcnt vmcnt(13)
  v_mfma_f32_16x16x32_bf16 v[16:19], v[24:27], v[120:123], 0
  v_mfma_f32_16x16x32_bf16 v[16:19], v[28:31], v[124:127], v[16:19]
  v_mfma_f32_16x16x32_bf16 v[16:19], v[32:35], v[128:131], v[16:19]
  v_mfma_f32_16x16x32_bf16 v[16:19], v[36:39], v[132:135], v[16:19]
  s_nop 7
  v_mov_b32_dpp v10, v16 quad_perm:[0,0,0,0] row_mask:0xf bank_mask:0xf
  v_add_f32_dpp v10, v17, v10 quad_perm:[1,1,1,1] row_mask:0xf bank_mask:0xf
  v_add_f32_dpp v10, v18, v10 quad_perm:[2,2,2,2] row_mask:0xf bank_mask:0xf
  v_add_f32_dpp v10, v19, v10 quad_perm:[3,3,3,3] row_mask:0xf bank_mask:0xf
  v_cvt_pk_bf16_f32 v10, v10, v10
  v_and_b32 v10, s74, v10
  v_mul_f32 v10, s72, v10
  v_cvt_pk_bf16_f32 v184, v10, v10
  s_waitcnt vmcnt(8)
  v_mfma_f32_16x16x32_bf16 v[16:19], v[24:27], v[136:139], 0
  v_mfma_f32_16x16x32_bf16 v[16:19], v[28:31], v[140:143], v[16:19]
  v_mfma_f32_16x16x32_bf16 v[16:19], v[32:35], v[144:147], v[16:19]
  v_mfma_f32_16x16x32_bf16 v[16:19], v[36:39], v[148:151], v[16:19]
  s_nop 7
  v_mov_b32_dpp v10, v16 quad_perm:[0,0,0,0] row_mask:0xf bank_mask:0xf
  v_add_f32_dpp v10, v17, v10 quad_perm:[1,1,1,1] row_mask:0xf bank_mask:0xf
  v_add_f32_dpp v10, v18, v10 quad_perm:[2,2,2,2] row_mask:0xf bank_mask:0xf
  v_add_f32_dpp v10, v19, v10 quad_perm:[3,3,3,3] row_mask:0xf bank_mask:0xf
  v_cvt_pk_bf16_f32 v10, v10, v10
  v_and_b32 v10, s74, v10
  v_mul_f32 v10, s72, v10
  v_cvt_pk_bf16_f32 v10, v10, v10
  v_bfi_b32 v184, s74, v10, v184
  s_waitcnt vmcnt(4)
  v_mfma_f32_16x16x32_bf16 v[16:19], v[24:27], v[152:155], 0
  v_mfma_f32_16x16x32_bf16 v[16:19], v[28:31], v[156:159], v[16:19]
  v_mfma_f32_16x16x32_bf16 v[16:19], v[32:35], v[160:163], v[16:19]
  v_mfma_f32_16x16x32_bf16 v[16:19], v[36:39], v[164:167], v[16:19]
  s_add_u32 s67, s67, 0x20000
  s_add_u32 s96, s67, 0x10000
  buffer_load_dwordx4 v[56:59], v3, s[8:11], s67 offen offset:0 nt
  buffer_load_dwordx4 v[60:63], v3, s[8:11], s67 offen offset:1024 nt
  buffer_load_dwordx4 v[64:67], v3, s[8:11], s67 offen offset:2048 nt
  buffer_load_dwordx4 v[68:71], v3, s[8:11], s67 offen offset:3072 nt
  s_nop 3
  v_mov_b32_dpp v10, v16 quad_perm:[0,0,0,0] row_mask:0xf bank_mask:0xf
  v_add_f32_dpp v10, v17, v10 quad_perm:[1,1,1,1] row_mask:0xf bank_mask:0xf
  v_add_f32_dpp v10, v18, v10 quad_perm:[2,2,2,2] row_mask:0xf bank_mask:0xf
  v_add_f32_dpp v10, v19, v10 quad_perm:[3,3,3,3] row_mask:0xf bank_mask:0xf
  v_cvt_pk_bf16_f32 v10, v10, v10
  v_and_b32 v10, s74, v10
  v_mul_f32 v10, s72, v10
  v_cvt_pk_bf16_f32 v185, v10, v10
  s_waitcnt vmcnt(4)
  v_mfma_f32_16x16x32_bf16 v[16:19], v[24:27], v[168:171], 0
  v_mfma_f32_16x16x32_bf16 v[16:19], v[28:31], v[172:175], v[16:19]
  v_mfma_f32_16x16x32_bf16 v[16:19], v[32:35], v[176:179], v[16:19]
  v_mfma_f32_16x16x32_bf16 v[16:19], v[36:39], v[180:183], v[16:19]
  buffer_load_dwordx4 v[72:75], v3, s[8:11], s96 offen offset:0 nt
  buffer_load_dwordx4 v[76:79], v3, s[8:11], s96 offen offset:1024 nt
  buffer_load_dwordx4 v[80:83], v3, s[8:11], s96 offen offset:2048 nt
  buffer_load_dwordx4 v[84:87], v3, s[8:11], s96 offen offset:3072 nt
  s_nop 3
  v_mov_b32_dpp v10, v16 quad_perm:[0,0,0,0] row_mask:0xf bank_mask:0xf
  v_add_f32_dpp v10, v17, v10 quad_perm:[1,1,1,1] row_mask:0xf bank_mask:0xf
  v_add_f32_dpp v10, v18, v10 quad_perm:[2,2,2,2] row_mask:0xf bank_mask:0xf
  v_add_f32_dpp v10, v19, v10 quad_perm:[3,3,3,3] row_mask:0xf bank_mask:0xf
  v_cvt_pk_bf16_f32 v10, v10, v10
  v_and_b32 v10, s74, v10
  v_mul_f32 v10, s72, v10
  v_cvt_pk_bf16_f32 v10, v10, v10
  v_bfi_b32 v185, s74, v10, v185
  s_mov_b64 exec, s[90:91]
  ds_write_b64 v188, v[184:185]
  s_mov_b64 exec, -1
  v_add_u32 v188, 128, v188
  s_mul_i32 s66, s75, 0x9e3779b1
  s_bfe_u32 s65, s66, 0x80000
  v_mov_b32 v128, s65
  s_bfe_u32 s65, s66, 0x80008
  v_mov_b32 v129, s65
  s_bfe_u32 s65, s66, 0x80010
  v_mov_b32 v130, s65
  s_bfe_u32 s65, s66, 0x80018
  v_mov_b32 v131, s65
  s_mov_b32 s66, 0xffffff00
  v_lshlrev_b32 v120, 4, v0
  v_and_b32 v133, 7, v0
  v_lshlrev_b32 v133, 2, v133
  v_lshrrev_b32 v10, 2, v1
  v_lshl_add_u32 v11, v2, 3, v10
  v_mul_u32_u24 v11, 144, v11
  v_and_b32 v13, 3, v0
  v_lshl_add_u32 v122, v13, 3, v11
  v_add_u32 v122, 7424, v122
  s_lshl_b32 s65, s62, 5
  v_add_u32 v121, s65, v122
  v_lshrrev_b32 v11, 1, v13
  v_lshlrev_b32 v11, 4, v11
  v_lshl_add_u32 v11, v2, 5, v11
  v_lshl_add_u32 v11, v10, 1, v11
  v_and_b32 v12, 1, v0
  v_add_u32 v11, v11, v12
  s_mul_i32 s65, s62, 320
  v_lshl_add_u32 v123, v11, 1, s65
  v_mul_u32_u24 v11, 320, v13
  v_lshl_add_u32 v124, v2, 4, v11
  v_mul_u32_u24 v11, 2304, v1
  v_lshl_add_u32 v125, v2, 4, v11
  v_lshrrev_b32 v11, 2, v0
  v_mul_u32_u24 v11, 9216, v11
  v_lshl_add_u32 v126, v13, 4, v11
  v_lshl_add_u32 v127, v13, 2, v2
  v_lshlrev_b32 v127, 1, v127
  s_cmp_eq_u32 s69, s101
  s_cselect_b32 s100, 12, 14
  s_cselect_b32 s97, 13, 15
  s_mov_b32 s98, 0x2e80
  s_cselect_b32 s98, 0xa80, s98
  s_cmp_eq_u32 s77, 0
  s_mov_b32 s71, 4
  s_cbranch_scc1 L_kinit
  s_waitcnt vmcnt(4)
  v_mfma_f32_16x16x32_bf16 v[16:19], v[24:27], v[56:59], 0
  v_mfma_f32_16x16x32_bf16 v[16:19], v[28:31], v[60:63], v[16:19]
  v_mfma_f32_16x16x32_bf16 v[16:19], v[32:35], v[64:67], v[16:19]
  v_mfma_f32_16x16x32_bf16 v[16:19], v[36:39], v[68:71], v[16:19]
  buffer_load_dwordx4 v[56:59], v186, s[8:11], s67 offen offset:0 nt
  buffer_load_dwordx4 v[60:63], v186, s[8:11], s67 offen offset:1024 nt
  buffer_load_dwordx4 v[64:67], v186, s[8:11], s67 offen offset:2048 nt
  buffer_load_dwordx4 v[68:71], v186, s[8:11], s67 offen offset:3072 nt
  s_add_u32 s63, s81, 0
  s_lshl_b32 s64, s63, 10
  s_add_u32 m0, s64, 62720
  s_mul_i32 s64, s63, 73728
  s_add_u32 s64, s64, s95
  buffer_load_dwordx4 v15, s[16:19], s64 offen  lds
  v_mov_b32_dpp v10, v16 quad_perm:[0,0,0,0] row_mask:0xf bank_mask:0xf
  v_add_f32_dpp v10, v17, v10 quad_perm:[1,1,1,1] row_mask:0xf bank_mask:0xf
  v_add_f32_dpp v10, v18, v10 quad_perm:[2,2,2,2] row_mask:0xf bank_mask:0xf
  v_add_f32_dpp v10, v19, v10 quad_perm:[3,3,3,3] row_mask:0xf bank_mask:0xf
  v_cvt_pk_bf16_f32 v10, v10, v10
  v_and_b32 v10, s74, v10
  v_mul_f32 v10, s72, v10
  v_cvt_pk_bf16_f32 v184, v10, v10
  s_waitcnt vmcnt(5)
  v_mfma_f32_16x16x32_bf16 v[16:19], v[24:27], v[72:75], 0
  v_mfma_f32_16x16x32_bf16 v[16:19], v[28:31], v[76:79], v[16:19]
  v_mfma_f32_16x16x32_bf16 v[16:19], v[32:35], v[80:83], v[16:19]
  v_mfma_f32_16x16x32_bf16 v[16:19], v[36:39], v[84:87], v[16:19]
  buffer_load_dwordx4 v[72:75], v186, s[8:11], s96 offen offset:0 nt
  buffer_load_dwordx4 v[76:79], v186, s[8:11], s96 offen offset:1024 nt
  buffer_load_dwordx4 v[80:83], v186, s[8:11], s96 offen offset:2048 nt
  buffer_load_dwordx4 v[84:87], v186, s[8:11], s96 offen offset:3072 nt
  s_add_u32 s63, s81, 0
  s_lshl_b32 s64, s63, 10
  s_add_u32 m0, s64, 81152
  s_mul_i32 s64, s63, 73728
  s_add_u32 s64, s64, s95
  buffer_load_dwordx4 v15, s[20:23], s64 offen  lds
  v_mov_b32_dpp v10, v16 quad_perm:[0,0,0,0] row_mask:0xf bank_mask:0xf
  v_add_f32_dpp v10, v17, v10 quad_perm:[1,1,1,1] row_mask:0xf bank_mask:0xf
  v_add_f32_dpp v10, v18, v10 quad_perm:[2,2,2,2] row_mask:0xf bank_mask:0xf
  v_add_f32_dpp v10, v19, v10 quad_perm:[3,3,3,3] row_mask:0xf bank_mask:0xf
  v_cvt_pk_bf16_f32 v10, v10, v10
  v_and_b32 v10, s74, v10
  v_mul_f32 v10, s72, v10
  v_cvt_pk_bf16_f32 v10, v10, v10
  v_bfi_b32 v184, s74, v10, v184
  s_waitcnt vmcnt(6)
  v_mfma_f32_16x16x32_bf16 v[16:19], v[24:27], v[56:59], 0
  v_mfma_f32_16x16x32_bf16 v[16:19], v[28:31], v[60:63], v[16:19]
  v_mfma_f32_16x16x32_bf16 v[16:19], v[32:35], v[64:67], v[16:19]
  v_mfma_f32_16x16x32_bf16 v[16:19], v[36:39], v[68:71], v[16:19]
  s_add_u32 s67, s67, 0x20000
  s_add_u32 s96, s67, 0x10000
  buffer_load_dwordx4 v[56:59], v3, s[8:11], s67 offen offset:0 nt
  buffer_load_dwordx4 v[60:63], v3, s[8:11], s67 offen offset:1024 nt
  buffer_load_dwordx4 v[64:67], v3, s[8:11], s67 offen offset:2048 nt
  buffer_load_dwordx4 v[68:71], v3, s[8:11], s67 offen offset:3072 nt
  s_add_u32 s63, s81, 4
  s_lshl_b32 s64, s63, 10
  s_add_u32 m0, s64, 62720
  s_mul_i32 s64, s63, 73728
  s_add_u32 s64, s64, s95
  buffer_load_dwordx4 v15, s[16:19], s64 offen  lds
  v_mov_b32_dpp v10, v16 quad_perm:[0,0,0,0] row_mask:0xf bank_mask:0xf
  v_add_f32_dpp v10, v17, v10 quad_perm:[1,1,1,1] row_mask:0xf bank_mask:0xf
  v_add_f32_dpp v10, v18, v10 quad_perm:[2,2,2,2] row_mask:0xf bank_mask:0xf
  v_add_f32_dpp v10, v19, v10 quad_perm:[3,3,3,3] row_mask:0xf bank_mask:0xf
  v_cvt_pk_bf16_f32 v10, v10, v10
  v_and_b32 v10, s74, v10
  v_mul_f32 v10, s72, v10
  v_cvt_pk_bf16_f32 v185, v10, v10
  s_waitcnt vmcnt(6)
  v_mfma_f32_16x16x32_bf16 v[16:19], v[24:27], v[72:75], 0
  v_mfma_f32_16x16x32_bf16 v[16:19], v[28:31], v[76:79], v[16:19]
  v_mfma_f32_16x16x32_bf16 v[16:19], v[32:35], v[80:83], v[16:19]
  v_mfma_f32_16x16x32_bf16 v[16:19], v[36:39], v[84:87], v[16:19]
  buffer_load_dwordx4 v[72:75], v3, s[8:11], s96 offen offset:0 nt
  buffer_load_dwordx4 v[76:79], v3, s[8:11], s96 offen offset:1024 nt
  buffer_load_dwordx4 v[80:83], v3, s[8:11], s96 offen offset:2048 nt
  buffer_load_dwordx4 v[84:87], v3, s[8:11], s96 offen offset:3072 nt
  s_add_u32 s63, s81, 4
  s_lshl_b32 s64, s63, 10
  s_add_u32 m0, s64, 81152
  s_mul_i32 s64, s63, 73728
  s_add_u32 s64, s64, s95
  buffer_load_dwordx4 v15, s[20:23], s64 offen  lds
  v_mov_b32_dpp v10, v16 quad_perm:[0,0,0,0] row_mask:0xf bank_mask:0xf
  v_add_f32_dpp v10, v17, v10 quad_perm:[1,1,1,1] row_mask:0xf bank_mask:0xf
  v_add_f32_dpp v10, v18, v10 quad_perm:[2,2,2,2] row_mask:0xf bank_mask:0xf
  v_add_f32_dpp v10, v19, v10 quad_perm:[3,3,3,3] row_mask:0xf bank_mask:0xf
  v_cvt_pk_bf16_f32 v10, v10, v10
  v_and_b32 v10, s74, v10
  v_mul_f32 v10, s72, v10
  v_cvt_pk_bf16_f32 v10, v10, v10
  v_bfi_b32 v185, s74, v10, v185
  s_mov_b64 exec, s[90:91]
  ds_write_b64 v188, v[184:185]
  s_mov_b64 exec, -1
  v_add_u32 v188, 128, v188
  s_waitcnt vmcnt(6)
  v_mfma_f32_16x16x32_bf16 v[16:19], v[24:27], v[56:59], 0
  v_mfma_f32_16x16x32_bf16 v[16:19], v[28:31], v[60:63], v[16:19]
  v_mfma_f32_16x16x32_bf16 v[16:19], v[32:35], v[64:67], v[16:19]
  v_mfma_f32_16x16x32_bf16 v[16:19], v[36:39], v[68:71], v[16:19]
  buffer_load_dwordx4 v[56:59], v186, s[8:11], s67 offen offset:0 nt
  buffer_load_dwordx4 v[60:63], v186, s[8:11], s67 offen offset:1024 nt
  buffer_load_dwordx4 v[64:67], v186, s[8:11], s67 offen offset:2048 nt
  buffer_load_dwordx4 v[68:71], v186, s[8:11], s67 offen offset:3072 nt
  s_add_u32 s63, s81, 8
  s_lshl_b32 s64, s63, 10
  s_add_u32 m0, s64, 62720
  s_mul_i32 s64, s63, 73728
  s_add_u32 s64, s64, s95
  buffer_load_dwordx4 v15, s[16:19], s64 offen  lds
  v_mov_b32_dpp v10, v16 quad_perm:[0,0,0,0] row_mask:0xf bank_mask:0xf
  v_add_f32_dpp v10, v17, v10 quad_perm:[1,1,1,1] row_mask:0xf bank_mask:0xf
  v_add_f32_dpp v10, v18, v10 quad_perm:[2,2,2,2] row_mask:0xf bank_mask:0xf
  v_add_f32_dpp v10, v19, v10 quad_perm:[3,3,3,3] row_mask:0xf bank_mask:0xf
  v_cvt_pk_bf16_f32 v10, v10, v10
  v_and_b32 v10, s74, v10
  v_mul_f32 v10, s72, v10
  v_cvt_pk_bf16_f32 v184, v10, v10
  s_waitcnt vmcnt(6)
  v_mfma_f32_16x16x32_bf16 v[16:19], v[24:27], v[72:75], 0
  v_mfma_f32_16x16x32_bf16 v[16:19], v[28:31], v[76:79], v[16:19]
  v_mfma_f32_16x16x32_bf16 v[16:19], v[32:35], v[80:83], v[16:19]
  v_mfma_f32_16x16x32_bf16 v[16:19], v[36:39], v[84:87], v[16:19]
  buffer_load_dwordx4 v[72:75], v186, s[8:11], s96 offen offset:0 nt
  buffer_load_dwordx4 v[76:79], v186, s[8:11], s96 offen offset:1024 nt
  buffer_load_dwordx4 v[80:83], v186, s[8:11], s96 offen offset:2048 nt
  buffer_load_dwordx4 v[84:87], v186, s[8:11], s96 offen offset:3072 nt
  s_add_u32 s63, s81, 8
  s_lshl_b32 s64, s63, 10
  s_add_u32 m0, s64, 81152
  s_mul_i32 s64, s63, 73728
  s_add_u32 s64, s64, s95
  buffer_load_dwordx4 v15, s[20:23], s64 offen  lds
  v_mov_b32_dpp v10, v16 quad_perm:[0,0,0,0] row_mask:0xf bank_mask:0xf
  v_add_f32_dpp v10, v17, v10 quad_perm:[1,1,1,1] row_mask:0xf bank_mask:0xf
  v_add_f32_dpp v10, v18, v10 quad_perm:[2,2,2,2] row_mask:0xf bank_mask:0xf
  v_add_f32_dpp v10, v19, v10 quad_perm:[3,3,3,3] row_mask:0xf bank_mask:0xf
  v_cvt_pk_bf16_f32 v10, v10, v10
  v_and_b32 v10, s74, v10
  v_mul_f32 v10, s72, v10
  v_cvt_pk_bf16_f32 v10, v10, v10
  v_bfi_b32 v184, s74, v10, v184
  s_waitcnt vmcnt(6)
  v_mfma_f32_16x16x32_bf16 v[16:19], v[24:27], v[56:59], 0
  v_mfma_f32_16x16x32_bf16 v[16:19], v[28:31], v[60:63], v[16:19]
  v_mfma_f32_16x16x32_bf16 v[16:19], v[32:35], v[64:67], v[16:19]
  v_mfma_f32_16x16x32_bf16 v[16:19], v[36:39], v[68:71], v[16:19]
  s_add_u32 s67, s67, 0x20000
  s_add_u32 s96, s67, 0x10000
  buffer_load_dwordx4 v[56:59], v3, s[8:11], s67 offen offset:0 nt
  buffer_load_dwordx4 v[60:63], v3, s[8:11], s67 offen offset:1024 nt
  buffer_load_dwordx4 v[64:67], v3, s[8:11], s67 offen offset:2048 nt
  buffer_load_dwordx4 v[68:71], v3, s[8:11], s67 offen offset:3072 nt
  s_add_u32 s63, s81, 12
  s_lshl_b32 s64, s63, 10
  s_add_u32 m0, s64, 62720
  s_mul_i32 s64, s63, 73728
  s_add_u32 s64, s64, s95
  buffer_load_dwordx4 v15, s[16:19], s64 offen  lds
  v_mov_b32_dpp v10, v16 quad_perm:[0,0,0,0] row_mask:0xf bank_mask:0xf
  v_add_f32_dpp v10, v17, v10 quad_perm:[1,1,1,1] row_mask:0xf bank_mask:0xf
  v_add_f32_dpp v10, v18, v10 quad_perm:[2,2,2,2] row_mask:0xf bank_mask:0xf
  v_add_f32_dpp v10, v19, v10 quad_perm:[3,3,3,3] row_mask:0xf bank_mask:0xf
  v_cvt_pk_bf16_f32 v10, v10, v10
  v_and_b32 v10, s74, v10
  v_mul_f32 v10, s72, v10
  v_cvt_pk_bf16_f32 v185, v10, v10
  s_waitcnt vmcnt(6)
  v_mfma_f32_16x16x32_bf16 v[16:19], v[24:27], v[72:75], 0
  v_mfma_f32_16x16x32_bf16 v[16:19], v[28:31], v[76:79], v[16:19]
  v_mfma_f32_16x16x32_bf16 v[16:19], v[32:35], v[80:83], v[16:19]
  v_mfma_f32_16x16x32_bf16 v[16:19], v[36:39], v[84:87], v[16:19]
  buffer_load_dwordx4 v[72:75], v3, s[8:11], s96 offen offset:0 nt
  buffer_load_dwordx4 v[76:79], v3, s[8:11], s96 offen offset:1024 nt
  buffer_load_dwordx4 v[80:83], v3, s[8:11], s96 offen offset:2048 nt
  buffer_load_dwordx4 v[84:87], v3, s[8:11], s96 offen offset:3072 nt
  s_add_u32 s63, s81, 12
  s_lshl_b32 s64, s63, 10
  s_add_u32 m0, s64, 81152
  s_mul_i32 s64, s63, 73728
  s_add_u32 s64, s64, s95
  buffer_load_dwordx4 v15, s[20:23], s64 offen  lds
  v_mov_b32_dpp v10, v16 quad_perm:[0,0,0,0] row_mask:0xf bank_mask:0xf
  v_add_f32_dpp v10, v17, v10 quad_perm:[1,1,1,1] row_mask:0xf bank_mask:0xf
  v_add_f32_dpp v10, v18, v10 quad_perm:[2,2,2,2] row_mask:0xf bank_mask:0xf
  v_add_f32_dpp v10, v19, v10 quad_perm:[3,3,3,3] row_mask:0xf bank_mask:0xf
  v_cvt_pk_bf16_f32 v10, v10, v10
  v_and_b32 v10, s74, v10
  v_mul_f32 v10, s72, v10
  v_cvt_pk_bf16_f32 v10, v10, v10
  v_bfi_b32 v185, s74, v10, v185
  s_mov_b64 exec, s[90:91]
  ds_write_b64 v188, v[184:185]
  s_mov_b64 exec, -1
  v_add_u32 v188, 128, v188
  s_waitcnt vmcnt(6)
  v_mfma_f32_16x16x32_bf16 v[16:19], v[24:27], v[56:59], 0
  v_mfma_f32_16x16x32_bf16 v[16:19], v[28:31], v[60:63], v[16:19]
  v_mfma_f32_16x16x32_bf16 v[16:19], v[32:35], v[64:67], v[16:19]
  v_mfma_f32_16x16x32_bf16 v[16:19], v[36:39], v[68:71], v[16:19]
  buffer_load_dwordx4 v[56:59], v186, s[8:11], s67 offen offset:0 nt
  buffer_load_dwordx4 v[60:63], v186, s[8:11], s67 offen offset:1024 nt
  buffer_load_dwordx4 v[64:67], v186, s[8:11], s67 offen offset:2048 nt
  buffer_load_dwordx4 v[68:71], v186, s[8:11], s67 offen offset:3072 nt
  s_add_u32 s63, s81, 16
  s_lshl_b32 s64, s63, 10
  s_add_u32 m0, s64, 62720
  s_mul_i32 s64, s63, 73728
  s_add_u32 s64, s64, s95
  s_cmp_lt_u32 s63, 18
  s_cselect_b32 s64, s64, 0x40000000
  s_cselect_b32 m0, m0, 121088
  s_nop 0
  buffer_load_dwordx4 v15, s[16:19], s64 offen  lds
  v_mov_b32_dpp v10, v16 quad_perm:[0,0,0,0] row_mask:0xf bank_mask:0xf
  v_add_f32_dpp v10, v17, v10 quad_perm:[1,1,1,1] row_mask:0xf bank_mask:0xf
  v_add_f32_dpp v10, v18, v10 quad_perm:[2,2,2,2] row_mask:0xf bank_mask:0xf
  v_add_f32_dpp v10, v19, v10 quad_perm:[3,3,3,3] row_mask:0xf bank_mask:0xf
  v_cvt_pk_bf16_f32 v10, v10, v10
  v_and_b32 v10, s74, v10
  v_mul_f32 v10, s72, v10
  v_cvt_pk_bf16_f32 v184, v10, v10
  s_waitcnt vmcnt(6)
  v_mfma_f32_16x16x32_bf16 v[16:19], v[24:27], v[72:75], 0
  v_mfma_f32_16x16x32_bf16 v[16:19], v[28:31], v[76:79], v[16:19]
  v_mfma_f32_16x16x32_bf16 v[16:19], v[32:35], v[80:83], v[16:19]
  v_mfma_f32_16x16x32_bf16 v[16:19], v[36:39], v[84:87], v[16:19]
  buffer_load_dwordx4 v[72:75], v186, s[8:11], s96 offen offset:0 nt
  buffer_load_dwordx4 v[76:79], v186, s[8:11], s96 offen offset:1024 nt
  buffer_load_dwordx4 v[80:83], v186, s[8:11], s96 offen offset:2048 nt
  buffer_load_dwordx4 v[84:87], v186, s[8:11], s96 offen offset:3072 nt
  s_add_u32 s63, s81, 16
  s_lshl_b32 s64, s63, 10
  s_add_u32 m0, s64, 81152
  s_mul_i32 s64, s63, 73728
  s_add_u32 s64, s64, s95
  s_cmp_lt_u32 s63, 18
  s_cselect_b32 s64, s64, 0x40000000
  s_cselect_b32 m0, m0, 121088
  s_nop 0
  buffer_load_dwordx4 v15, s[20:23], s64 offen  lds
  v_mov_b32_dpp v10, v16 quad_perm:[0,0,0,0] row_mask:0xf bank_mask:0xf
  v_add_f32_dpp v10, v17, v10 quad_perm:[1,1,1,1] row_mask:0xf bank_mask:0xf
  v_add_f32_dpp v10, v18, v10 quad_perm:[2,2,2,2] row_mask:0xf bank_mask:0xf
  v_add_f32_dpp v10, v19, v10 quad_perm:[3,3,3,3] row_mask:0xf bank_mask:0xf
  v_cvt_pk_bf16_f32 v10, v10, v10
  v_and_b32 v10, s74, v10
  v_mul_f32 v10, s72, v10
  v_cvt_pk_bf16_f32 v10, v10, v10
  v_bfi_b32 v184, s74, v10, v184
  s_waitcnt vmcnt(6)
  v_mfma_f32_16x16x32_bf16 v[16:19], v[24:27], v[56:59], 0
  v_mfma_f32_16x16x32_bf16 v[16:19], v[28:31], v[60:63], v[16:19]
  v_mfma_f32_16x16x32_bf16 v[16:19], v[32:35], v[64:67], v[16:19]
  v_mfma_f32_16x16x32_bf16 v[16:19], v[36:39], v[68:71], v[16:19]
  s_add_u32 s67, s67, 0x20000
  s_add_u32 s96, s67, 0x10000
  buffer_load_dwordx4 v[56:59], v3, s[8:11], s67 offen offset:0 nt
  buffer_load_dwordx4 v[60:63], v3, s[8:11], s67 offen offset:1024 nt
  buffer_load_dwordx4 v[64:67], v3, s[8:11], s67 offen offset:2048 nt
  buffer_load_dwordx4 v[68:71], v3, s[8:11], s67 offen offset:3072 nt
  s_nop 3
  v_mov_b32_dpp v10, v16 quad_perm:[0,0,0,0] row_mask:0xf bank_mask:0xf
  v_add_f32_dpp v10, v17, v10 quad_perm:[1,1,1,1] row_mask:0xf bank_mask:0xf
  v_add_f32_dpp v10, v18, v10 quad_perm:[2,2,2,2] row_mask:0xf bank_mask:0xf
  v_add_f32_dpp v10, v19, v10 quad_perm:[3,3,3,3] row_mask:0xf bank_mask:0xf
  v_cvt_pk_bf16_f32 v10, v10, v10
  v_and_b32 v10, s74, v10
  v_mul_f32 v10, s72, v10
  v_cvt_pk_bf16_f32 v185, v10, v10
  s_waitcnt vmcnt(5)
  v_mfma_f32_16x16x32_bf16 v[16:19], v[24:27], v[72:75], 0
  v_mfma_f32_16x16x32_bf16 v[16:19], v[28:31], v[76:79], v[16:19]
  v_mfma_f32_16x16x32_bf16 v[16:19], v[32:35], v[80:83], v[16:19]
  v_mfma_f32_16x16x32_bf16 v[16:19], v[36:39], v[84:87], v[16:19]
  buffer_load_dwordx4 v[72:75], v3, s[8:11], s96 offen offset:0 nt
  buffer_load_dwordx4 v[76:79], v3, s[8:11], s96 offen offset:1024 nt
  buffer_load_dwordx4 v[80:83], v3, s[8:11], s96 offen offset:2048 nt
  buffer_load_dwordx4 v[84:87], v3, s[8:11], s96 offen offset:3072 nt
  s_nop 3
  v_mov_b32_dpp v10, v16 quad_perm:[0,0,0,0] row_mask:0xf bank_mask:0xf
  v_add_f32_dpp v10, v17, v10 quad_perm:[1,1,1,1] row_mask:0xf bank_mask:0xf
  v_add_f32_dpp v10, v18, v10 quad_perm:[2,2,2,2] row_mask:0xf bank_mask:0xf
  v_add_f32_dpp v10, v19, v10 quad_perm:[3,3,3,3] row_mask:0xf bank_mask:0xf
  v_cvt_pk_bf16_f32 v10, v10, v10
  v_and_b32 v10, s74, v10
  v_mul_f32 v10, s72, v10
  v_cvt_pk_bf16_f32 v10, v10, v10
  v_bfi_b32 v185, s74, v10, v185
  s_mov_b64 exec, s[90:91]
  ds_write_b64 v188, v[184:185]
  s_mov_b64 exec, -1
  v_add_u32 v188, 128, v188
  s_waitcnt vmcnt(8)
  v_mov_b32 v11, 7168
  v_mov_b32 v13, 1
  s_mov_b64 exec, 1
  ds_add_u32 v11, v13 offset:4
  s_mov_b64 exec, -1
  s_mov_b32 s71, 7
L_kinit:
  s_mov_b32 s92, 0x20000
  s_mov_b32 s93, 0
  s_and_b32 s95, s69, 2
  s_lshl_b32 s95, s95, 5
  s_add_u32 s95, s95, s70
  s_add_u32 s95, s95, 128
L_kloop:
  s_bitcmp1_b32 s98, s71
  s_cbranch_scc1 L_kmark
L_kret:
  s_waitcnt vmcnt(4)
  v_mfma_f32_16x16x32_bf16 v[16:19], v[24:27], v[56:59], 0
  v_mfma_f32_16x16x32_bf16 v[16:19], v[28:31], v[60:63], v[16:19]
  v_mfma_f32_16x16x32_bf16 v[16:19], v[32:35], v[64:67], v[16:19]
  v_mfma_f32_16x16x32_bf16 v[16:19], v[36:39], v[68:71], v[16:19]
  buffer_load_dwordx4 v[56:59], v186, s[8:11], s67 offen offset:0 nt
  buffer_load_dwordx4 v[60:63], v186, s[8:11], s67 offen offset:1024 nt
  buffer_load_dwordx4 v[64:67], v186, s[8:11], s67 offen offset:2048 nt
  buffer_load_dwordx4 v[68:71], v186, s[8:11], s67 offen offset:3072 nt
  s_nop 3
  v_mov_b32_dpp v10, v16 quad_perm:[0,0,0,0] row_mask:0xf bank_mask:0xf
  v_add_f32_dpp v10, v17, v10 quad_perm:[1,1,1,1] row_mask:0xf bank_mask:0xf
  v_add_f32_dpp v10, v18, v10 quad_perm:[2,2,2,2] row_mask:0xf bank_mask:0xf
  v_add_f32_dpp v10, v19, v10 quad_perm:[3,3,3,3] row_mask:0xf bank_mask:0xf
  v_cvt_pk_bf16_f32 v10, v10, v10
  v_and_b32 v10, s74, v10
  v_mul_f32 v10, s72, v10
  v_cvt_pk_bf16_f32 v184, v10, v10
  s_waitcnt vmcnt(4)
  v_mfma_f32_16x16x32_bf16 v[16:19], v[24:27], v[72:75], 0
  v_mfma_f32_16x16x32_bf16 v[16:19], v[28:31], v[76:79], v[16:19]
  v_mfma_f32_16x16x32_bf16 v[16:19], v[32:35], v[80:83], v[16:19]
  v_mfma_f32_16x16x32_bf16 v[16:19], v[36:39], v[84:87], v[16:19]
  buffer_load_dwordx4 v[72:75], v186, s[8:11], s96 offen offset:0 nt
  buffer_load_dwordx4 v[76:79], v186, s[8:11], s96 offen offset:1024 nt
  buffer_load_dwordx4 v[80:83], v186, s[8:11], s96 offen offset:2048 nt
  buffer_load_dwordx4 v[84:87], v186, s[8:11], s96 offen offset:3072 nt
  s_nop 3
  v_mov_b32_dpp v10, v16 quad_perm:[0,0,0,0] row_mask:0xf bank_mask:0xf
  v_add_f32_dpp v10, v17, v10 quad_perm:[1,1,1,1] row_mask:0xf bank_mask:0xf
  v_add_f32_dpp v10, v18, v10 quad_perm:[2,2,2,2] row_mask:0xf bank_mask:0xf
  v_add_f32_dpp v10, v19, v10 quad_perm:[3,3,3,3] row_mask:0xf bank_mask:0xf
  v_cvt_pk_bf16_f32 v10, v10, v10
  v_and_b32 v10, s74, v10
  v_mul_f32 v10, s72, v10
  v_cvt_pk_bf16_f32 v10, v10, v10
  v_bfi_b32 v184, s74, v10, v184
  s_waitcnt vmcnt(4)
  v_mfma_f32_16x16x32_bf16 v[16:19], v[24:27], v[56:59], 0
  v_mfma_f32_16x16x32_bf16 v[16:19], v[28:31], v[60:63], v[16:19]
  v_mfma_f32_16x16x32_bf16 v[16:19], v[32:35], v[64:67], v[16:19]
  v_mfma_f32_16x16x32_bf16 v[16:19], v[36:39], v[68:71], v[16:19]
  s_add_u32 s67, s67, s92
  s_add_u32 s96, s67, 0x10000
  buffer_load_dwordx4 v[56:59], v3, s[8:11], s67 offen offset:0 nt
  buffer_load_dwordx4 v[60:63], v3, s[8:11], s67 offen offset:1024 nt
  buffer_load_dwordx4 v[64:67], v3, s[8:11], s67 offen offset:2048 nt
  buffer_load_dwordx4 v[68:71], v3, s[8:11], s67 offen offset:3072 nt
  s_nop 3
  v_mov_b32_dpp v10, v16 quad_perm:[0,0,0,0] row_mask:0xf bank_mask:0xf
  v_add_f32_dpp v10, v17, v10 quad_perm:[1,1,1,1] row_mask:0xf bank_mask:0xf
  v_add_f32_dpp v10, v18, v10 quad_perm:[2,2,2,2] row_mask:0xf bank_mask:0xf
  v_add_f32_dpp v10, v19, v10 quad_perm:[3,3,3,3] row_mask:0xf bank_mask:0xf
  v_cvt_pk_bf16_f32 v10, v10, v10
  v_and_b32 v10, s74, v10
  v_mul_f32 v10, s72, v10
  v_cvt_pk_bf16_f32 v185, v10, v10
  s_waitcnt vmcnt(4)
  v_mfma_f32_16x16x32_bf16 v[16:19], v[24:27], v[72:75], 0
  v_mfma_f32_16x16x32_bf16 v[16:19], v[28:31], v[76:79], v[16:19]
  v_mfma_f32_16x16x32_bf16 v[16:19], v[32:35], v[80:83], v[16:19]
  v_mfma_f32_16x16x32_bf16 v[16:19], v[36:39], v[84:87], v[16:19]
  buffer_load_dwordx4 v[72:75], v3, s[8:11], s96 offen offset:0 nt
  buffer_load_dwordx4 v[76:79], v3, s[8:11], s96 offen offset:1024 nt
  buffer_load_dwordx4 v[80:83], v3, s[8:11], s96 offen offset:2048 nt
  buffer_load_dwordx4 v[84:87], v3, s[8:11], s96 offen offset:3072 nt
  s_nop 3
  v_mov_b32_dpp v10, v16 quad_perm:[0,0,0,0] row_mask:0xf bank_mask:0xf
  v_add_f32_dpp v10, v17, v10 quad_perm:[1,1,1,1] row_mask:0xf bank_mask:0xf
  v_add_f32_dpp v10, v18, v10 quad_perm:[2,2,2,2] row_mask:0xf bank_mask:0xf
  v_add_f32_dpp v10, v19, v10 quad_perm:[3,3,3,3] row_mask:0xf bank_mask:0xf
  v_cvt_pk_bf16_f32 v10, v10, v10
  v_and_b32 v10, s74, v10
  v_mul_f32 v10, s72, v10
  v_cvt_pk_bf16_f32 v10, v10, v10
  v_bfi_b32 v185, s74, v10, v185
  s_mov_b64 exec, s[90:91]
  ds_write_b64 v188, v[184:185]
  s_mov_b64 exec, -1
  v_add_u32 v188, 128, v188
  s_add_u32 s71, s71, 1
  s_cmp_lt_u32 s71, s100
  s_cbranch_scc1 L_kloop
  s_waitcnt lgkmcnt(0)
  s_cmp_ge_u32 s94, 4
  s_cbranch_scc1 L_kdone
  s_sub_u32 s65, s71, s100
  s_lshl_b32 s65, s65, 2
  s_lshl_b32 s63, s94, s65
  s_or_b32 s93, s93, s63
  s_lshr_b32 s63, s94, 2
  s_add_u32 s63, s63, s97
  s_lshl_b32 s63, s63, 5
  s_and_b32 s64, s94, 1
  s_or_b32 s63, s63, s64
  s_and_b32 s64, s94, 2
  s_lshl_b32 s64, s64, 1
  s_or_b32 s63, s63, s64
  s_and_b32 s64, s69, 2
  s_or_b32 s63, s63, s64
  s_lshl_b32 s63, s63, 12
  s_add_u32 s63, s63, s68
  s_sub_u32 s92, s63, s67
  s_mov_b32 s94, 4
  s_cmp_ge_u32 s65, 28
  s_cbranch_scc1 L_kloop
  s_mov_b32 s94, 1
  s_atomic_add s94, s[58:59], s95 glc
  s_branch L_kloop
L_kdone:
  s_cmp_eq_u32 s69, s101
  s_cbranch_scc1 L_kl_same
L_fa:
  v_cmp_ne_u32 vcc, s75, v132
  s_cbranch_vccz L_fa_ok
  s_sub_u32 s76, s76, 1
  s_cmp_le_i32 s76, 0
  s_cbranch_scc1 L_fa_ok
  s_sleep 4
  s_lshl_b32 s66, s101, 2
  s_add_u32 s66, s66, s80
  v_mov_b32 v13, 0
  buffer_load_dword v132, v13, s[24:27], s66 offen offset:0 sc1
  s_waitcnt vmcnt(0)
  s_branch L_fa
L_fa_ok:
  s_mul_i32 s63, s81, 2560
  s_add_u32 s63, s63, 122112
  s_add_u32 m0, s63, 128
  s_lshl_b32 s64, s101, 11
  s_add_u32 s64, s64, s89
  s_add_u32 s64, s64, 128
  buffer_load_dwordx4 v120, s[24:27], s64 offen sc1 nt lds
L_kl_same:
  s_sub_u32 s94, s71, s100
  s_cmp_eq_u32 s69, s101
  s_cselect_b32 s63, s61, s101
  s_cselect_b32 s64, 0, 1
  s_cselect_b32 s100, s71, 12
  s_mov_b32 s98, 0x1c4
  s_cselect_b32 s98, 0xfffff403, s98
  s_mov_b32 s71, s64
  s_lshl_b32 s99, s63, 12
  s_add_u32 s99, s99, s68
  s_lshl_b32 s65, s64, 17
  s_add_u32 s99, s99, s65
  s_lshl_b32 s64, s64, 7
  s_mul_i32 s63, s81, 2560
  s_add_u32 s63, s63, 122112
  s_add_u32 s63, s63, s64
  v_add_u32 v156, s63, v187
  s_waitcnt vmcnt(4)
  v_mfma_f32_16x16x32_bf16 v[16:19], v[24:27], v[56:59], 0
  v_mfma_f32_16x16x32_bf16 v[16:19], v[28:31], v[60:63], v[16:19]
  v_mfma_f32_16x16x32_bf16 v[16:19], v[32:35], v[64:67], v[16:19]
  v_mfma_f32_16x16x32_bf16 v[16:19], v[36:39], v[68:71], v[16:19]
  buffer_load_dwordx4 v[56:59], v186, s[8:11], s67 offen offset:0 nt
  buffer_load_dwordx4 v[60:63], v186, s[8:11], s67 offen offset:1024 nt
  buffer_load_dwordx4 v[64:67], v186, s[8:11], s67 offen offset:2048 nt
  buffer_load_dwordx4 v[68:71], v186, s[8:11], s67 offen offset:3072 nt
  s_nop 3
  v_mov_b32_dpp v10, v16 quad_perm:[0,0,0,0] row_mask:0xf bank_mask:0xf
  v_add_f32_dpp v10, v17, v10 quad_perm:[1,1,1,1] row_mask:0xf bank_mask:0xf
  v_add_f32_dpp v10, v18, v10 quad_perm:[2,2,2,2] row_mask:0xf bank_mask:0xf
  v_add_f32_dpp v10, v19, v10 quad_perm:[3,3,3,3] row_mask:0xf bank_mask:0xf
  v_cvt_pk_bf16_f32 v10, v10, v10
  v_and_b32 v10, s74, v10
  v_mul_f32 v10, s72, v10
  v_cvt_pk_bf16_f32 v184, v10, v10
  s_waitcnt vmcnt(4)
  v_mfma_f32_16x16x32_bf16 v[16:19], v[24:27], v[72:75], 0
  v_mfma_f32_16x16x32_bf16 v[16:19], v[28:31], v[76:79], v[16:19]
  v_mfma_f32_16x16x32_bf16 v[16:19], v[32:35], v[80:83], v[16:19]
  v_mfma_f32_16x16x32_bf16 v[16:19], v[36:39], v[84:87], v[16:19]
  buffer_load_dwordx4 v[72:75], v186, s[8:11], s96 offen offset:0 nt
  buffer_load_dwordx4 v[76:79], v186, s[8:11], s96 offen offset:1024 nt
  buffer_load_dwordx4 v[80:83], v186, s[8:11], s96 offen offset:2048 nt
  buffer_load_dwordx4 v[84:87], v186, s[8:11], s96 offen offset:3072 nt
  s_nop 3
  v_mov_b32_dpp v10, v16 quad_perm:[0,0,0,0] row_mask:0xf bank_mask:0xf
  v_add_f32_dpp v10, v17, v10 quad_perm:[1,1,1,1] row_mask:0xf bank_mask:0xf
  v_add_f32_dpp v10, v18, v10 quad_perm:[2,2,2,2] row_mask:0xf bank_mask:0xf
  v_add_f32_dpp v10, v19, v10 quad_perm:[3,3,3,3] row_mask:0xf bank_mask:0xf
  v_cvt_pk_bf16_f32 v10, v10, v10
  v_and_b32 v10, s74, v10
  v_mul_f32 v10, s72, v10
  v_cvt_pk_bf16_f32 v10, v10, v10
  v_bfi_b32 v184, s74, v10, v184
  s_mov_b32 s96, 0x20000
  s_waitcnt vmcnt(4)
  v_mfma_f32_16x16x32_bf16 v[16:19], v[24:27], v[56:59], 0
  v_mfma_f32_16x16x32_bf16 v[16:19], v[28:31], v[60:63], v[16:19]
  v_mfma_f32_16x16x32_bf16 v[16:19], v[32:35], v[64:67], v[16:19]
  v_mfma_f32_16x16x32_bf16 v[16:19], v[36:39], v[68:71], v[16:19]
  ds_read_b64 v[152:153], v156
  v_add_u32 v156, 128, v156
  s_add_u32 s97, s99, 0x0
  s_xor_b32 s66, s97, 0x8100
  buffer_load_dwordx4 v[56:59], v4, s[12:15], s97 offen offset:0 nt
  buffer_load_dwordx4 v[60:63], v4, s[12:15], s66 offen offset:0 nt
  buffer_load_dwordx4 v[64:67], v4, s[12:15], s97 offen offset:512 nt
  buffer_load_dwordx4 v[68:71], v4, s[12:15], s66 offen offset:512 nt
  s_nop 3
  v_mov_b32_dpp v10, v16 quad_perm:[0,0,0,0] row_mask:0xf bank_mask:0xf
  v_add_f32_dpp v10, v17, v10 quad_perm:[1,1,1,1] row_mask:0xf bank_mask:0xf
  v_add_f32_dpp v10, v18, v10 quad_perm:[2,2,2,2] row_mask:0xf bank_mask:0xf
  v_add_f32_dpp v10, v19, v10 quad_perm:[3,3,3,3] row_mask:0xf bank_mask:0xf
  v_cvt_pk_bf16_f32 v10, v10, v10
  v_and_b32 v10, s74, v10
  v_mul_f32 v10, s72, v10
  v_cvt_pk_bf16_f32 v185, v10, v10
  s_waitcnt vmcnt(4)
  v_mfma_f32_16x16x32_bf16 v[16:19], v[24:27], v[72:75], 0
  v_mfma_f32_16x16x32_bf16 v[16:19], v[28:31], v[76:79], v[16:19]
  v_mfma_f32_16x16x32_bf16 v[16:19], v[32:35], v[80:83], v[16:19]
  v_mfma_f32_16x16x32_bf16 v[16:19], v[36:39], v[84:87], v[16:19]
  s_add_u32 s97, s99, 0x10000
  s_xor_b32 s66, s97, 0x8100
  buffer_load_dwordx4 v[72:75], v4, s[12:15], s97 offen offset:0 nt
  buffer_load_dwordx4 v[76:79], v4, s[12:15], s66 offen offset:0 nt
  buffer_load_dwordx4 v[80:83], v4, s[12:15], s97 offen offset:512 nt
  buffer_load_dwordx4 v[84:87], v4, s[12:15], s66 offen offset:512 nt
  s_nop 3
  v_mov_b32_dpp v10, v16 quad_perm:[0,0,0,0] row_mask:0xf bank_mask:0xf
  v_add_f32_dpp v10, v17, v10 quad_perm:[1,1,1,1] row_mask:0xf bank_mask:0xf
  v_add_f32_dpp v10, v18, v10 quad_perm:[2,2,2,2] row_mask:0xf bank_mask:0xf
  v_add_f32_dpp v10, v19, v10 quad_perm:[3,3,3,3] row_mask:0xf bank_mask:0xf
  v_cvt_pk_bf16_f32 v10, v10, v10
  v_and_b32 v10, s74, v10
  v_mul_f32 v10, s72, v10
  v_cvt_pk_bf16_f32 v10, v10, v10
  v_bfi_b32 v185, s74, v10, v185
  s_mov_b64 exec, s[90:91]
  ds_write_b64 v188, v[184:185]
  s_mov_b64 exec, -1
  v_add_u32 v188, 128, v188
  s_cmp_eq_u32 s69, s101
  s_cbranch_scc1 L_vloop
  s_mul_i32 s63, s81, 2560
  s_add_u32 s63, s63, 122112
  s_lshl_b32 s64, s69, 11
  s_lshl_b32 s65, s61, 11
  s_sub_u32 s65, s65, 768
  s_add_u32 s64, s64, 1152
  v_cmp_gt_u32 vcc, 48, v0
  v_mov_b32 v13, s65
  v_mov_b32 v11, s64
  v_cndmask_b32 v13, v13, v11, vcc
  v_add_u32 v13, v13, v120
  v_mov_b32 v11, -768
  v_mov_b32 v12, 1152
  v_cndmask_b32 v11, v11, v12, vcc
  v_add3_u32 v11, v11, v120, s63
  s_waitcnt lgkmcnt(0)
  ds_read_b128 v[136:139], v11
  v_add_u32 v11, s63, v120
  s_mov_b32 exec_hi, 0
  ds_read_b128 v[140:143], v11 offset:1920
  s_mov_b32 exec_hi, -1
  v_lshrrev_b32 v11, 3, v0
  v_lshlrev_b32 v11, 2, v11
  v_lshrrev_b32 v11, v11, s93
  v_and_b32 v12, 2, v11
  v_and_b32 v11, 1, v11
  v_lshl_add_u32 v11, v12, 1, v11
  s_and_b32 s64, s69, 2
  v_add_u32 v11, s64, v11
  v_lshlrev_b32 v11, 11, v11
  v_lshl_add_u32 v11, v133, 2, v11
  s_lshl_b32 s64, s94, 3
  s_bfm_b64 exec, s64, 0
  s_waitcnt lgkmcnt(0)
  s_cbranch_execz L_noextra
  buffer_store_dwordx4 v[140:143], v11, s[24:27], s89 offen offset:1920 sc1 nt
L_noextra:
  s_mov_b32 exec_lo, -1
  s_mov_b32 exec_hi, 0xffffff
  s_waitcnt lgkmcnt(0)
  buffer_store_dwordx4 v[136:139], v13, s[24:27], s89 offen offset:0 sc1 nt
  s_mov_b64 exec, -1
L_vloop:
  s_bitcmp1_b32 s98, s71
  s_cbranch_scc1 L_vmark
L_vret:
  s_waitcnt lgkmcnt(0)
  v_mov_b32 v154, v152
  v_mov_b32 v155, v153
  v_lshlrev_b32 v10, 16, v154
  v_cmp_gt_f32 vcc, v10, v5
  s_cbranch_vccnz L_rare_1
L_ret_2:
  v_fma_f32 v12, v10, s73, v6
  v_exp_f32 v12, v12
  s_nop 0
  v_cvt_pk_bf16_f32 v11, v12, v12
  v_and_b32 v11, v8, v11
  v_sub_f32 v11, v12, v11
  v_cvt_pk_bf16_f32 v11, v11, v11
  v_and_b32 v14, v9, v11
  v_add_f32 v7, v7, v12
  s_nop 0
  v_mov_b32_dpp v40, v14 quad_perm:[0,1,2,3] row_mask:0xf bank_mask:0x1
  v_mov_b32_dpp v41, v14 row_ror:4 row_mask:0xf bank_mask:0x2
  v_mov_b32_dpp v42, v14 row_ror:8 row_mask:0xf bank_mask:0x4
  v_mov_b32_dpp v43, v14 row_ror:12 row_mask:0xf bank_mask:0x8
  v_mov_b32_dpp v44, v14 row_ror:12 row_mask:0xf bank_mask:0x1
  v_mov_b32_dpp v45, v14 quad_perm:[0,1,2,3] row_mask:0xf bank_mask:0x2
  v_mov_b32_dpp v46, v14 row_ror:4 row_mask:0xf bank_mask:0x4
  v_mov_b32_dpp v47, v14 row_ror:8 row_mask:0xf bank_mask:0x8
  v_mov_b32_dpp v48, v14 row_ror:8 row_mask:0xf bank_mask:0x1
  v_mov_b32_dpp v49, v14 row_ror:12 row_mask:0xf bank_mask:0x2
  v_mov_b32_dpp v50, v14 quad_perm:[0,1,2,3] row_mask:0xf bank_mask:0x4
  v_mov_b32_dpp v51, v14 row_ror:4 row_mask:0xf bank_mask:0x8
  v_mov_b32_dpp v52, v14 row_ror:4 row_mask:0xf bank_mask:0x1
  v_mov_b32_dpp v53, v14 row_ror:8 row_mask:0xf bank_mask:0x2
  v_mov_b32_dpp v54, v14 row_ror:12 row_mask:0xf bank_mask:0x4
  v_mov_b32_dpp v55, v14 quad_perm:[0,1,2,3] row_mask:0xf bank_mask:0x8
  s_waitcnt vmcnt(4)
  v_mfma_f32_16x16x32_bf16 v[20:23], v[56:59], v[40:43], v[20:23]
  v_mfma_f32_16x16x32_bf16 v[20:23], v[60:63], v[44:47], v[20:23]
  v_mfma_f32_16x16x32_bf16 v[20:23], v[64:67], v[48:51], v[20:23]
  v_mfma_f32_16x16x32_bf16 v[20:23], v[68:71], v[52:55], v[20:23]
  s_add_u32 s97, s99, 0x100
  s_xor_b32 s66, s97, 0x8100
  buffer_load_dwordx4 v[56:59], v4, s[12:15], s97 offen offset:0 nt
  buffer_load_dwordx4 v[60:63], v4, s[12:15], s66 offen offset:0 nt
  buffer_load_dwordx4 v[64:67], v4, s[12:15], s97 offen offset:512 nt
  buffer_load_dwordx4 v[68:71], v4, s[12:15], s66 offen offset:512 nt
  v_and_b32 v10, s74, v154
  v_cmp_gt_f32 vcc, v10, v5
  s_cbranch_vccnz L_rare_3
L_ret_4:
  v_fma_f32 v12, v10, s73, v6
  v_exp_f32 v12, v12
  s_nop 0
  v_cvt_pk_bf16_f32 v11, v12, v12
  v_and_b32 v11, v8, v11
  v_sub_f32 v11, v12, v11
  v_cvt_pk_bf16_f32 v11, v11, v11
  v_and_b32 v14, v9, v11
  v_add_f32 v7, v7, v12
  s_nop 0
  v_mov_b32_dpp v40, v14 quad_perm:[0,1,2,3] row_mask:0xf bank_mask:0x1
  v_mov_b32_dpp v41, v14 row_ror:4 row_mask:0xf bank_mask:0x2
  v_mov_b32_dpp v42, v14 row_ror:8 row_mask:0xf bank_mask:0x4
  v_mov_b32_dpp v43, v14 row_ror:12 row_mask:0xf bank_mask:0x8
  v_mov_b32_dpp v44, v14 row_ror:12 row_mask:0xf bank_mask:0x1
  v_mov_b32_dpp v45, v14 quad_perm:[0,1,2,3] row_mask:0xf bank_mask:0x2
  v_mov_b32_dpp v46, v14 row_ror:4 row_mask:0xf bank_mask:0x4
  v_mov_b32_dpp v47, v14 row_ror:8 row_mask:0xf bank_mask:0x8
  v_mov_b32_dpp v48, v14 row_ror:8 row_mask:0xf bank_mask:0x1
  v_mov_b32_dpp v49, v14 row_ror:12 row_mask:0xf bank_mask:0x2
  v_mov_b32_dpp v50, v14 quad_perm:[0,1,2,3] row_mask:0xf bank_mask:0x4
  v_mov_b32_dpp v51, v14 row_ror:4 row_mask:0xf bank_mask:0x8
  v_mov_b32_dpp v52, v14 row_ror:4 row_mask:0xf bank_mask:0x1
  v_mov_b32_dpp v53, v14 row_ror:8 row_mask:0xf bank_mask:0x2
  v_mov_b32_dpp v54, v14 row_ror:12 row_mask:0xf bank_mask:0x4
  v_mov_b32_dpp v55, v14 quad_perm:[0,1,2,3] row_mask:0xf bank_mask:0x8
  s_waitcnt vmcnt(4)
  v_mfma_f32_16x16x32_bf16 v[20:23], v[72:75], v[40:43], v[20:23]
  v_mfma_f32_16x16x32_bf16 v[20:23], v[76:79], v[44:47], v[20:23]
  v_mfma_f32_16x16x32_bf16 v[20:23], v[80:83], v[48:51], v[20:23]
  v_mfma_f32_16x16x32_bf16 v[20:23], v[84:87], v[52:55], v[20:23]
  s_add_u32 s97, s99, 0x10100
  s_xor_b32 s66, s97, 0x8100
  buffer_load_dwordx4 v[72:75], v4, s[12:15], s97 offen offset:0 nt
  buffer_load_dwordx4 v[76:79], v4, s[12:15], s66 offen offset:0 nt
  buffer_load_dwordx4 v[80:83], v4, s[12:15], s97 offen offset:512 nt
  buffer_load_dwordx4 v[84:87], v4, s[12:15], s66 offen offset:512 nt
  v_lshlrev_b32 v10, 16, v155
  v_cmp_gt_f32 vcc, v10, v5
  s_cbranch_vccnz L_rare_5
L_ret_6:
  v_fma_f32 v12, v10, s73, v6
  v_exp_f32 v12, v12
  s_nop 0
  v_cvt_pk_bf16_f32 v11, v12, v12
  v_and_b32 v11, v8, v11
  v_sub_f32 v11, v12, v11
  v_cvt_pk_bf16_f32 v11, v11, v11
  v_and_b32 v14, v9, v11
  v_add_f32 v7, v7, v12
  s_nop 0
  v_mov_b32_dpp v40, v14 quad_perm:[0,1,2,3] row_mask:0xf bank_mask:0x1
  v_mov_b32_dpp v41, v14 row_ror:4 row_mask:0xf bank_mask:0x2
  v_mov_b32_dpp v42, v14 row_ror:8 row_mask:0xf bank_mask:0x4
  v_mov_b32_dpp v43, v14 row_ror:12 row_mask:0xf bank_mask:0x8
  v_mov_b32_dpp v44, v14 row_ror:12 row_mask:0xf bank_mask:0x1
  v_mov_b32_dpp v45, v14 quad_perm:[0,1,2,3] row_mask:0xf bank_mask:0x2
  v_mov_b32_dpp v46, v14 row_ror:4 row_mask:0xf bank_mask:0x4
  v_mov_b32_dpp v47, v14 row_ror:8 row_mask:0xf bank_mask:0x8
  v_mov_b32_dpp v48, v14 row_ror:8 row_mask:0xf bank_mask:0x1
  v_mov_b32_dpp v49, v14 row_ror:12 row_mask:0xf bank_mask:0x2
  v_mov_b32_dpp v50, v14 quad_perm:[0,1,2,3] row_mask:0xf bank_mask:0x4
  v_mov_b32_dpp v51, v14 row_ror:4 row_mask:0xf bank_mask:0x8
  v_mov_b32_dpp v52, v14 row_ror:4 row_mask:0xf bank_mask:0x1
  v_mov_b32_dpp v53, v14 row_ror:8 row_mask:0xf bank_mask:0x2
  v_mov_b32_dpp v54, v14 row_ror:12 row_mask:0xf bank_mask:0x4
  v_mov_b32_dpp v55, v14 quad_perm:[0,1,2,3] row_mask:0xf bank_mask:0x8
  s_waitcnt vmcnt(4)
  v_mfma_f32_16x16x32_bf16 v[20:23], v[56:59], v[40:43], v[20:23]
  v_mfma_f32_16x16x32_bf16 v[20:23], v[60:63], v[44:47], v[20:23]
  v_mfma_f32_16x16x32_bf16 v[20:23], v[64:67], v[48:51], v[20:23]
  v_mfma_f32_16x16x32_bf16 v[20:23], v[68:71], v[52:55], v[20:23]
  ds_read_b64 v[152:153], v156
  v_add_u32 v156, 128, v156
  s_add_u32 s99, s99, s96
  s_add_u32 s97, s99, 0x0
  s_xor_b32 s66, s97, 0x8100
  buffer_load_dwordx4 v[56:59], v4, s[12:15], s97 offen offset:0 nt
  buffer_load_dwordx4 v[60:63], v4, s[12:15], s66 offen offset:0 nt
  buffer_load_dwordx4 v[64:67], v4, s[12:15], s97 offen offset:512 nt
  buffer_load_dwordx4 v[68:71], v4, s[12:15], s66 offen offset:512 nt
  v_and_b32 v10, s74, v155
  v_cmp_gt_f32 vcc, v10, v5
  s_cbranch_vccnz L_rare_7
L_ret_8:
  v_fma_f32 v12, v10, s73, v6
  v_exp_f32 v12, v12
  s_nop 0
  v_cvt_pk_bf16_f32 v11, v12, v12
  v_and_b32 v11, v8, v11
  v_sub_f32 v11, v12, v11
  v_cvt_pk_bf16_f32 v11, v11, v11
  v_and_b32 v14, v9, v11
  v_add_f32 v7, v7, v12
  s_nop 0
  v_mov_b32_dpp v40, v14 quad_perm:[0,1,2,3] row_mask:0xf bank_mask:0x1
  v_mov_b32_dpp v41, v14 row_ror:4 row_mask:0xf bank_mask:0x2
  v_mov_b32_dpp v42, v14 row_ror:8 row_mask:0xf bank_mask:0x4
  v_mov_b32_dpp v43, v14 row_ror:12 row_mask:0xf bank_mask:0x8
  v_mov_b32_dpp v44, v14 row_ror:12 row_mask:0xf bank_mask:0x1
  v_mov_b32_dpp v45, v14 quad_perm:[0,1,2,3] row_mask:0xf bank_mask:0x2
  v_mov_b32_dpp v46, v14 row_ror:4 row_mask:0xf bank_mask:0x4
  v_mov_b32_dpp v47, v14 row_ror:8 row_mask:0xf bank_mask:0x8
  v_mov_b32_dpp v48, v14 row_ror:8 row_mask:0xf bank_mask:0x1
  v_mov_b32_dpp v49, v14 row_ror:12 row_mask:0xf bank_mask:0x2
  v_mov_b32_dpp v50, v14 quad_perm:[0,1,2,3] row_mask:0xf bank_mask:0x4
  v_mov_b32_dpp v51, v14 row_ror:4 row_mask:0xf bank_mask:0x8
  v_mov_b32_dpp v52, v14 row_ror:4 row_mask:0xf bank_mask:0x1
  v_mov_b32_dpp v53, v14 row_ror:8 row_mask:0xf bank_mask:0x2
  v_mov_b32_dpp v54, v14 row_ror:12 row_mask:0xf bank_mask:0x4
  v_mov_b32_dpp v55, v14 quad_perm:[0,1,2,3] row_mask:0xf bank_mask:0x8
  s_waitcnt vmcnt(4)
  v_mfma_f32_16x16x32_bf16 v[20:23], v[72:75], v[40:43], v[20:23]
  v_mfma_f32_16x16x32_bf16 v[20:23], v[76:79], v[44:47], v[20:23]
  v_mfma_f32_16x16x32_bf16 v[20:23], v[80:83], v[48:51], v[20:23]
  v_mfma_f32_16x16x32_bf16 v[20:23], v[84:87], v[52:55], v[20:23]
  s_add_u32 s97, s99, 0x10000
  s_xor_b32 s66, s97, 0x8100
  buffer_load_dwordx4 v[72:75], v4, s[12:15], s97 offen offset:0 nt
  buffer_load_dwordx4 v[76:79], v4, s[12:15], s66 offen offset:0 nt
  buffer_load_dwordx4 v[80:83], v4, s[12:15], s97 offen offset:512 nt
  buffer_load_dwordx4 v[84:87], v4, s[12:15], s66 offen offset:512 nt
  s_add_u32 s71, s71, 1
  s_cmp_lt_u32 s71, s100
  s_cbranch_scc1 L_vloop
  s_lshl_b32 s65, s60, 2
  s_add_u32 s65, s65, s62
  s_lshl_b32 s65, s65, 3
  s_add_u32 s65, s65, s61
  s_lshl_b32 s92, s65, 10
  s_add_u32 s92, s92, 0x400000
  s_lshl_b32 s65, s87, 2
  s_add_u32 s65, s65, s62
  s_lshl_b32 s93, s65, 13
  s_add_u32 s93, s93, 0x400000
  s_waitcnt lgkmcnt(0)
  v_mov_b32 v154, v152
  v_mov_b32 v155, v153
  s_sub_u32 s98, s69, s101
  s_mov_b32 s82, 1
  s_mov_b32 s71, 0
  s_mov_b32 s69, 1
  s_atomic_add s69, s[58:59], s70 glc
  v_lshlrev_b32 v10, 16, v154
  v_cmp_gt_f32 vcc, v10, v5
  s_cbranch_vccnz L_rare_9
L_ret_10:
  v_fma_f32 v12, v10, s73, v6
  v_exp_f32 v12, v12
  s_nop 0
  v_cvt_pk_bf16_f32 v11, v12, v12
  v_and_b32 v11, v8, v11
  v_sub_f32 v11, v12, v11
  v_cvt_pk_bf16_f32 v11, v11, v11
  v_and_b32 v14, v9, v11
  v_add_f32 v7, v7, v12
  s_nop 0
  v_mov_b32_dpp v40, v14 quad_perm:[0,1,2,3] row_mask:0xf bank_mask:0x1
  v_mov_b32_dpp v41, v14 row_ror:4 row_mask:0xf bank_mask:0x2
  v_mov_b32_dpp v42, v14 row_ror:8 row_mask:0xf bank_mask:0x4
  v_mov_b32_dpp v43, v14 row_ror:12 row_mask:0xf bank_mask:0x8
  v_mov_b32_dpp v44, v14 row_ror:12 row_mask:0xf bank_mask:0x1
  v_mov_b32_dpp v45, v14 quad_perm:[0,1,2,3] row_mask:0xf bank_mask:0x2
  v_mov_b32_dpp v46, v14 row_ror:4 row_mask:0xf bank_mask:0x4
  v_mov_b32_dpp v47, v14 row_ror:8 row_mask:0xf bank_mask:0x8
  v_mov_b32_dpp v48, v14 row_ror:8 row_mask:0xf bank_mask:0x1
  v_mov_b32_dpp v49, v14 row_ror:12 row_mask:0xf bank_mask:0x2
  v_mov_b32_dpp v50, v14 quad_perm:[0,1,2,3] row_mask:0xf bank_mask:0x4
  v_mov_b32_dpp v51, v14 row_ror:4 row_mask:0xf bank_mask:0x8
  v_mov_b32_dpp v52, v14 row_ror:4 row_mask:0xf bank_mask:0x1
  v_mov_b32_dpp v53, v14 row_ror:8 row_mask:0xf bank_mask:0x2
  v_mov_b32_dpp v54, v14 row_ror:12 row_mask:0xf bank_mask:0x4
  v_mov_b32_dpp v55, v14 quad_perm:[0,1,2,3] row_mask:0xf bank_mask:0x8
  s_waitcnt vmcnt(4)
  v_mfma_f32_16x16x32_bf16 v[20:23], v[56:59], v[40:43], v[20:23]
  v_mfma_f32_16x16x32_bf16 v[20:23], v[60:63], v[44:47], v[20:23]
  v_mfma_f32_16x16x32_bf16 v[20:23], v[64:67], v[48:51], v[20:23]
  v_mfma_f32_16x16x32_bf16 v[20:23], v[68:71], v[52:55], v[20:23]
  s_add_u32 s97, s99, 0x100
  s_xor_b32 s66, s97, 0x8100
  buffer_load_dwordx4 v[56:59], v4, s[12:15], s97 offen offset:0 nt
  buffer_load_dwordx4 v[60:63], v4, s[12:15], s66 offen offset:0 nt
  buffer_load_dwordx4 v[64:67], v4, s[12:15], s97 offen offset:512 nt
  buffer_load_dwordx4 v[68:71], v4, s[12:15], s66 offen offset:512 nt
  v_and_b32 v10, s74, v154
  v_cmp_gt_f32 vcc, v10, v5
  s_cbranch_vccnz L_rare_11
L_ret_12:
  v_fma_f32 v12, v10, s73, v6
  v_exp_f32 v12, v12
  s_nop 0
  v_cvt_pk_bf16_f32 v11, v12, v12
  v_and_b32 v11, v8, v11
  v_sub_f32 v11, v12, v11
  v_cvt_pk_bf16_f32 v11, v11, v11
  v_and_b32 v14, v9, v11
  v_add_f32 v7, v7, v12
  s_nop 0
  v_mov_b32_dpp v40, v14 quad_perm:[0,1,2,3] row_mask:0xf bank_mask:0x1
  v_mov_b32_dpp v41, v14 row_ror:4 row_mask:0xf bank_mask:0x2
  v_mov_b32_dpp v42, v14 row_ror:8 row_mask:0xf bank_mask:0x4
  v_mov_b32_dpp v43, v14 row_ror:12 row_mask:0xf bank_mask:0x8
  v_mov_b32_dpp v44, v14 row_ror:12 row_mask:0xf bank_mask:0x1
  v_mov_b32_dpp v45, v14 quad_perm:[0,1,2,3] row_mask:0xf bank_mask:0x2
  v_mov_b32_dpp v46, v14 row_ror:4 row_mask:0xf bank_mask:0x4
  v_mov_b32_dpp v47, v14 row_ror:8 row_mask:0xf bank_mask:0x8
  v_mov_b32_dpp v48, v14 row_ror:8 row_mask:0xf bank_mask:0x1
  v_mov_b32_dpp v49, v14 row_ror:12 row_mask:0xf bank_mask:0x2
  v_mov_b32_dpp v50, v14 quad_perm:[0,1,2,3] row_mask:0xf bank_mask:0x4
  v_mov_b32_dpp v51, v14 row_ror:4 row_mask:0xf bank_mask:0x8
  v_mov_b32_dpp v52, v14 row_ror:4 row_mask:0xf bank_mask:0x1
  v_mov_b32_dpp v53, v14 row_ror:8 row_mask:0xf bank_mask:0x2
  v_mov_b32_dpp v54, v14 row_ror:12 row_mask:0xf bank_mask:0x4
  v_mov_b32_dpp v55, v14 quad_perm:[0,1,2,3] row_mask:0xf bank_mask:0x8
  s_waitcnt vmcnt(4)
  v_mfma_f32_16x16x32_bf16 v[20:23], v[72:75], v[40:43], v[20:23]
  v_mfma_f32_16x16x32_bf16 v[20:23], v[76:79], v[44:47], v[20:23]
  v_mfma_f32_16x16x32_bf16 v[20:23], v[80:83], v[48:51], v[20:23]
  v_mfma_f32_16x16x32_bf16 v[20:23], v[84:87], v[52:55], v[20:23]
  s_add_u32 s97, s99, 0x10100
  s_xor_b32 s66, s97, 0x8100
  buffer_load_dwordx4 v[72:75], v4, s[12:15], s97 offen offset:0 nt
  buffer_load_dwordx4 v[76:79], v4, s[12:15], s66 offen offset:0 nt
  buffer_load_dwordx4 v[80:83], v4, s[12:15], s97 offen offset:512 nt
  buffer_load_dwordx4 v[84:87], v4, s[12:15], s66 offen offset:512 nt
  v_mov_b32 v154, v155
  s_cmp_eq_u32 s98, 0
  s_cbranch_scc1 L_fused
  v_lshlrev_b32 v10, 16, v154
  v_cmp_gt_f32 vcc, v10, v5
  s_cbranch_vccnz L_rare_13
L_ret_14:
  v_fma_f32 v12, v10, s73, v6
  v_exp_f32 v12, v12
  s_nop 0
  v_cvt_pk_bf16_f32 v11, v12, v12
  v_and_b32 v11, v8, v11
  v_sub_f32 v11, v12, v11
  v_cvt_pk_bf16_f32 v11, v11, v11
  v_and_b32 v14, v9, v11
  v_add_f32 v7, v7, v12
  s_nop 0
  v_mov_b32_dpp v40, v14 quad_perm:[0,1,2,3] row_mask:0xf bank_mask:0x1
  v_mov_b32_dpp v41, v14 row_ror:4 row_mask:0xf bank_mask:0x2
  v_mov_b32_dpp v42, v14 row_ror:8 row_mask:0xf bank_mask:0x4
  v_mov_b32_dpp v43, v14 row_ror:12 row_mask:0xf bank_mask:0x8
  v_mov_b32_dpp v44, v14 row_ror:12 row_mask:0xf bank_mask:0x1
  v_mov_b32_dpp v45, v14 quad_perm:[0,1,2,3] row_mask:0xf bank_mask:0x2
  v_mov_b32_dpp v46, v14 row_ror:4 row_mask:0xf bank_mask:0x4
  v_mov_b32_dpp v47, v14 row_ror:8 row_mask:0xf bank_mask:0x8
  v_mov_b32_dpp v48, v14 row_ror:8 row_mask:0xf bank_mask:0x1
  v_mov_b32_dpp v49, v14 row_ror:12 row_mask:0xf bank_mask:0x2
  v_mov_b32_dpp v50, v14 quad_perm:[0,1,2,3] row_mask:0xf bank_mask:0x4
  v_mov_b32_dpp v51, v14 row_ror:4 row_mask:0xf bank_mask:0x8
  v_mov_b32_dpp v52, v14 row_ror:4 row_mask:0xf bank_mask:0x1
  v_mov_b32_dpp v53, v14 row_ror:8 row_mask:0xf bank_mask:0x2
  v_mov_b32_dpp v54, v14 row_ror:12 row_mask:0xf bank_mask:0x4
  v_mov_b32_dpp v55, v14 quad_perm:[0,1,2,3] row_mask:0xf bank_mask:0x8
  s_waitcnt vmcnt(4)
  v_mfma_f32_16x16x32_bf16 v[20:23], v[56:59], v[40:43], v[20:23]
  v_mfma_f32_16x16x32_bf16 v[20:23], v[60:63], v[44:47], v[20:23]
  v_mfma_f32_16x16x32_bf16 v[20:23], v[64:67], v[48:51], v[20:23]
  v_mfma_f32_16x16x32_bf16 v[20:23], v[68:71], v[52:55], v[20:23]
  s_cmp_lg_u32 s71, 0
  s_cbranch_scc1 L_next_15
  s_waitcnt lgkmcnt(0)
  s_sub_u32 s83, s69, 1
  s_mov_b32 s71, s82
L_next_15:
  s_add_u32 s83, s83, 1
  s_sub_u32 s71, s71, 1
  s_cmp_ge_u32 s83, 64
  s_cbranch_scc1 L_last
  s_cmp_lg_u32 s71, 0
  s_cbranch_scc1 L_have_16
  s_sub_u32 s82, 64, s83
  s_lshr_b32 s82, s82, 4
  s_min_u32 s82, s82, 3
  s_max_u32 s82, s82, 1
  s_mov_b32 s69, s82
  s_atomic_add s69, s[58:59], s70 glc
L_have_16:
  s_lshr_b32 s63, s83, 1
  s_add_u32 s63, s63, 104
  s_and_b32 s63, s63, 127
  s_and_b32 s64, s63, 7
  s_lshl_b32 s64, s64, 4
  s_lshr_b32 s65, s63, 3
  s_add_u32 s65, s65, s64
  s_and_b32 s64, s83, 1
  s_lshl_b32 s65, s65, 5
  s_add_u32 s65, s65, s64
  s_lshl_b32 s65, s65, 2
  s_add_u32 s65, s65, s89
  buffer_load_dword v152, v187, s[24:27], s65 offen sc1
  s_lshr_b32 s65, s63, 3
  s_lshl_b32 s65, s65, 17
  s_and_b32 s63, s63, 7
  s_lshl_b32 s63, s63, 12
  s_lshl_b32 s64, s64, 8
  s_add_u32 s63, s63, s65
  s_add_u32 s63, s63, s64
  s_add_u32 s97, s63, s68
  s_xor_b32 s66, s97, 0x8100
  buffer_load_dwordx4 v[56:59], v4, s[12:15], s97 offen offset:0 nt
  buffer_load_dwordx4 v[60:63], v4, s[12:15], s66 offen offset:0 nt
  buffer_load_dwordx4 v[64:67], v4, s[12:15], s97 offen offset:512 nt
  buffer_load_dwordx4 v[68:71], v4, s[12:15], s66 offen offset:512 nt
L_second:
  v_and_b32 v10, s74, v154
  v_cmp_gt_f32 vcc, v10, v5
  s_cbranch_vccnz L_rare_17
L_ret_18:
  v_fma_f32 v12, v10, s73, v6
  v_exp_f32 v12, v12
  s_nop 0
  v_cvt_pk_bf16_f32 v11, v12, v12
  v_and_b32 v11, v8, v11
  v_sub_f32 v11, v12, v11
  v_cvt_pk_bf16_f32 v11, v11, v11
  v_and_b32 v14, v9, v11
  v_add_f32 v7, v7, v12
  s_nop 0
  v_mov_b32_dpp v40, v14 quad_perm:[0,1,2,3] row_mask:0xf bank_mask:0x1
  v_mov_b32_dpp v41, v14 row_ror:4 row_mask:0xf bank_mask:0x2
  v_mov_b32_dpp v42, v14 row_ror:8 row_mask:0xf bank_mask:0x4
  v_mov_b32_dpp v43, v14 row_ror:12 row_mask:0xf bank_mask:0x8
  v_mov_b32_dpp v44, v14 row_ror:12 row_mask:0xf bank_mask:0x1
  v_mov_b32_dpp v45, v14 quad_perm:[0,1,2,3] row_mask:0xf bank_mask:0x2
  v_mov_b32_dpp v46, v14 row_ror:4 row_mask:0xf bank_mask:0x4
  v_mov_b32_dpp v47, v14 row_ror:8 row_mask:0xf bank_mask:0x8
  v_mov_b32_dpp v48, v14 row_ror:8 row_mask:0xf bank_mask:0x1
  v_mov_b32_dpp v49, v14 row_ror:12 row_mask:0xf bank_mask:0x2
  v_mov_b32_dpp v50, v14 quad_perm:[0,1,2,3] row_mask:0xf bank_mask:0x4
  v_mov_b32_dpp v51, v14 row_ror:4 row_mask:0xf bank_mask:0x8
  v_mov_b32_dpp v52, v14 row_ror:4 row_mask:0xf bank_mask:0x1
  v_mov_b32_dpp v53, v14 row_ror:8 row_mask:0xf bank_mask:0x2
  v_mov_b32_dpp v54, v14 row_ror:12 row_mask:0xf bank_mask:0x4
  v_mov_b32_dpp v55, v14 quad_perm:[0,1,2,3] row_mask:0xf bank_mask:0x8
  s_waitcnt vmcnt(5)
  v_mfma_f32_16x16x32_bf16 v[20:23], v[72:75], v[40:43], v[20:23]
  v_mfma_f32_16x16x32_bf16 v[20:23], v[76:79], v[44:47], v[20:23]
  v_mfma_f32_16x16x32_bf16 v[20:23], v[80:83], v[48:51], v[20:23]
  v_mfma_f32_16x16x32_bf16 v[20:23], v[84:87], v[52:55], v[20:23]
  s_add_u32 s97, s97, 0x10000
  s_add_u32 s66, s66, 0x10000
  buffer_load_dwordx4 v[72:75], v4, s[12:15], s97 offen offset:0 nt
  buffer_load_dwordx4 v[76:79], v4, s[12:15], s66 offen offset:0 nt
  buffer_load_dwordx4 v[80:83], v4, s[12:15], s97 offen offset:512 nt
  buffer_load_dwordx4 v[84:87], v4, s[12:15], s66 offen offset:512 nt
  s_waitcnt vmcnt(8)
  v_mov_b32 v154, v152
  v_lshlrev_b32 v10, 16, v154
  v_cmp_gt_f32 vcc, v10, v5
  s_cbranch_vccnz L_rare_19
L_ret_20:
  v_fma_f32 v12, v10, s73, v6
  v_exp_f32 v12, v12
  s_nop 0
  v_cvt_pk_bf16_f32 v11, v12, v12
  v_and_b32 v11, v8, v11
  v_sub_f32 v11, v12, v11
  v_cvt_pk_bf16_f32 v11, v11, v11
  v_and_b32 v14, v9, v11
  v_add_f32 v7, v7, v12
  s_nop 0
  v_mov_b32_dpp v40, v14 quad_perm:[0,1,2,3] row_mask:0xf bank_mask:0x1
  v_mov_b32_dpp v41, v14 row_ror:4 row_mask:0xf bank_mask:0x2
  v_mov_b32_dpp v42, v14 row_ror:8 row_mask:0xf bank_mask:0x4
  v_mov_b32_dpp v43, v14 row_ror:12 row_mask:0xf bank_mask:0x8
  v_mov_b32_dpp v44, v14 row_ror:12 row_mask:0xf bank_mask:0x1
  v_mov_b32_dpp v45, v14 quad_perm:[0,1,2,3] row_mask:0xf bank_mask:0x2
  v_mov_b32_dpp v46, v14 row_ror:4 row_mask:0xf bank_mask:0x4
  v_mov_b32_dpp v47, v14 row_ror:8 row_mask:0xf bank_mask:0x8
  v_mov_b32_dpp v48, v14 row_ror:8 row_mask:0xf bank_mask:0x1
  v_mov_b32_dpp v49, v14 row_ror:12 row_mask:0xf bank_mask:0x2
  v_mov_b32_dpp v50, v14 quad_perm:[0,1,2,3] row_mask:0xf bank_mask:0x4
  v_mov_b32_dpp v51, v14 row_ror:4 row_mask:0xf bank_mask:0x8
  v_mov_b32_dpp v52, v14 row_ror:4 row_mask:0xf bank_mask:0x1
  v_mov_b32_dpp v53, v14 row_ror:8 row_mask:0xf bank_mask:0x2
  v_mov_b32_dpp v54, v14 row_ror:12 row_mask:0xf bank_mask:0x4
  v_mov_b32_dpp v55, v14 quad_perm:[0,1,2,3] row_mask:0xf bank_mask:0x8
  s_waitcnt vmcnt(4)
  v_mfma_f32_16x16x32_bf16 v[20:23], v[56:59], v[40:43], v[20:23]
  v_mfma_f32_16x16x32_bf16 v[20:23], v[60:63], v[44:47], v[20:23]
  v_mfma_f32_16x16x32_bf16 v[20:23], v[64:67], v[48:51], v[20:23]
  v_mfma_f32_16x16x32_bf16 v[20:23], v[68:71], v[52:55], v[20:23]
  s_cmp_lg_u32 s71, 0
  s_cbranch_scc1 L_next_21
  s_waitcnt lgkmcnt(0)
  s_sub_u32 s83, s69, 1
  s_mov_b32 s71, s82
L_next_21:
  s_add_u32 s83, s83, 1
  s_sub_u32 s71, s71, 1
  s_cmp_ge_u32 s83, 64
  s_cbranch_scc1 L_last
  s_cmp_lg_u32 s71, 0
  s_cbranch_scc1 L_have_22
  s_sub_u32 s82, 64, s83
  s_lshr_b32 s82, s82, 4
  s_min_u32 s82, s82, 3
  s_max_u32 s82, s82, 1
  s_mov_b32 s69, s82
  s_atomic_add s69, s[58:59], s70 glc
L_have_22:
  s_lshr_b32 s63, s83, 1
  s_add_u32 s63, s63, 104
  s_and_b32 s63, s63, 127
  s_and_b32 s64, s63, 7
  s_lshl_b32 s64, s64, 4
  s_lshr_b32 s65, s63, 3
  s_add_u32 s65, s65, s64
  s_and_b32 s64, s83, 1
  s_lshl_b32 s65, s65, 5
  s_add_u32 s65, s65, s64
  s_lshl_b32 s65, s65, 2
  s_add_u32 s65, s65, s89
  buffer_load_dword v152, v187, s[24:27], s65 offen sc1
  s_lshr_b32 s65, s63, 3
  s_lshl_b32 s65, s65, 17
  s_and_b32 s63, s63, 7
  s_lshl_b32 s63, s63, 12
  s_lshl_b32 s64, s64, 8
  s_add_u32 s63, s63, s65
  s_add_u32 s63, s63, s64
  s_add_u32 s97, s63, s68
  s_xor_b32 s66, s97, 0x8100
  buffer_load_dwordx4 v[56:59], v4, s[12:15], s97 offen offset:0 nt
  buffer_load_dwordx4 v[60:63], v4, s[12:15], s66 offen offset:0 nt
  buffer_load_dwordx4 v[64:67], v4, s[12:15], s97 offen offset:512 nt
  buffer_load_dwordx4 v[68:71], v4, s[12:15], s66 offen offset:512 nt
  s_branch L_second
L_fused:
  v_lshlrev_b32 v10, 16, v154
  v_cmp_gt_f32 vcc, v10, v5
  s_cbranch_vccnz L_rare_23
L_ret_24:
  v_fma_f32 v12, v10, s73, v6
  v_exp_f32 v12, v12
  s_nop 0
  v_cvt_pk_bf16_f32 v11, v12, v12
  v_and_b32 v11, v8, v11
  v_sub_f32 v11, v12, v11
  v_cvt_pk_bf16_f32 v11, v11, v11
  v_and_b32 v14, v9, v11
  v_add_f32 v7, v7, v12
  s_nop 0
  v_mov_b32_dpp v40, v14 quad_perm:[0,1,2,3] row_mask:0xf bank_mask:0x1
  v_mov_b32_dpp v41, v14 row_ror:4 row_mask:0xf bank_mask:0x2
  v_mov_b32_dpp v42, v14 row_ror:8 row_mask:0xf bank_mask:0x4
  v_mov_b32_dpp v43, v14 row_ror:12 row_mask:0xf bank_mask:0x8
  v_mov_b32_dpp v44, v14 row_ror:12 row_mask:0xf bank_mask:0x1
  v_mov_b32_dpp v45, v14 quad_perm:[0,1,2,3] row_mask:0xf bank_mask:0x2
  v_mov_b32_dpp v46, v14 row_ror:4 row_mask:0xf bank_mask:0x4
  v_mov_b32_dpp v47, v14 row_ror:8 row_mask:0xf bank_mask:0x8
  v_mov_b32_dpp v48, v14 row_ror:8 row_mask:0xf bank_mask:0x1
  v_mov_b32_dpp v49, v14 row_ror:12 row_mask:0xf bank_mask:0x2
  v_mov_b32_dpp v50, v14 quad_perm:[0,1,2,3] row_mask:0xf bank_mask:0x4
  v_mov_b32_dpp v51, v14 row_ror:4 row_mask:0xf bank_mask:0x8
  v_mov_b32_dpp v52, v14 row_ror:4 row_mask:0xf bank_mask:0x1
  v_mov_b32_dpp v53, v14 row_ror:8 row_mask:0xf bank_mask:0x2
  v_mov_b32_dpp v54, v14 row_ror:12 row_mask:0xf bank_mask:0x4
  v_mov_b32_dpp v55, v14 quad_perm:[0,1,2,3] row_mask:0xf bank_mask:0x8
  s_waitcnt vmcnt(4)
  v_mfma_f32_16x16x32_bf16 v[20:23], v[56:59], v[40:43], v[20:23]
  v_mfma_f32_16x16x32_bf16 v[20:23], v[60:63], v[44:47], v[20:23]
  v_mfma_f32_16x16x32_bf16 v[20:23], v[64:67], v[48:51], v[20:23]
  v_mfma_f32_16x16x32_bf16 v[20:23], v[68:71], v[52:55], v[20:23]
  s_cmp_lg_u32 s71, 0
  s_cbranch_scc1 L_next_25
  s_waitcnt lgkmcnt(0)
  s_sub_u32 s83, s69, 1
  s_mov_b32 s71, s82
L_next_25:
  s_add_u32 s83, s83, 1
  s_sub_u32 s71, s71, 1
  s_cmp_ge_u32 s83, 64
  s_cbranch_scc1 L_last
  s_add_u32 s63, s83, 448
  s_and_b32 s64, s63, 7
  s_lshl_b32 s64, s64, 12
  s_add_u32 s64, s64, s68
  s_lshr_b32 s65, s63, 5
  s_lshl_b32 s65, s65, 17
  s_add_u32 s64, s64, s65
  s_and_b32 s65, s63, 8
  s_lshl_b32 s65, s65, 13
  s_add_u32 s67, s64, s65
  s_and_b32 s65, s63, 16
  s_lshl_b32 s65, s65, 4
  v_xor_b32 v156, s65, v3
  s_add_u32 s99, s67, s65
  buffer_load_dwordx4 v[56:59], v156, s[8:11], s67 offen offset:0 nt
  buffer_load_dwordx4 v[60:63], v156, s[8:11], s67 offen offset:1024 nt
  buffer_load_dwordx4 v[64:67], v156, s[8:11], s67 offen offset:2048 nt
  buffer_load_dwordx4 v[68:71], v156, s[8:11], s67 offen offset:3072 nt
  v_and_b32 v10, s74, v154
  v_cmp_gt_f32 vcc, v10, v5
  s_cbranch_vccnz L_rare_26
L_ret_27:
  v_fma_f32 v12, v10, s73, v6
  v_exp_f32 v12, v12
  s_nop 0
  v_cvt_pk_bf16_f32 v11, v12, v12
  v_and_b32 v11, v8, v11
  v_sub_f32 v11, v12, v11
  v_cvt_pk_bf16_f32 v11, v11, v11
  v_and_b32 v14, v9, v11
  v_add_f32 v7, v7, v12
  s_nop 0
  v_mov_b32_dpp v40, v14 quad_perm:[0,1,2,3] row_mask:0xf bank_mask:0x1
  v_mov_b32_dpp v41, v14 row_ror:4 row_mask:0xf bank_mask:0x2
  v_mov_b32_dpp v42, v14 row_ror:8 row_mask:0xf bank_mask:0x4
  v_mov_b32_dpp v43, v14 row_ror:12 row_mask:0xf bank_mask:0x8
  v_mov_b32_dpp v44, v14 row_ror:12 row_mask:0xf bank_mask:0x1
  v_mov_b32_dpp v45, v14 quad_perm:[0,1,2,3] row_mask:0xf bank_mask:0x2
  v_mov_b32_dpp v46, v14 row_ror:4 row_mask:0xf bank_mask:0x4
  v_mov_b32_dpp v47, v14 row_ror:8 row_mask:0xf bank_mask:0x8
  v_mov_b32_dpp v48, v14 row_ror:8 row_mask:0xf bank_mask:0x1
  v_mov_b32_dpp v49, v14 row_ror:12 row_mask:0xf bank_mask:0x2
  v_mov_b32_dpp v50, v14 quad_perm:[0,1,2,3] row_mask:0xf bank_mask:0x4
  v_mov_b32_dpp v51, v14 row_ror:4 row_mask:0xf bank_mask:0x8
  v_mov_b32_dpp v52, v14 row_ror:4 row_mask:0xf bank_mask:0x1
  v_mov_b32_dpp v53, v14 row_ror:8 row_mask:0xf bank_mask:0x2
  v_mov_b32_dpp v54, v14 row_ror:12 row_mask:0xf bank_mask:0x4
  v_mov_b32_dpp v55, v14 quad_perm:[0,1,2,3] row_mask:0xf bank_mask:0x8
  s_waitcnt vmcnt(4)
  v_mfma_f32_16x16x32_bf16 v[20:23], v[72:75], v[40:43], v[20:23]
  v_mfma_f32_16x16x32_bf16 v[20:23], v[76:79], v[44:47], v[20:23]
  v_mfma_f32_16x16x32_bf16 v[20:23], v[80:83], v[48:51], v[20:23]
  v_mfma_f32_16x16x32_bf16 v[20:23], v[84:87], v[52:55], v[20:23]
  s_mov_b32 s97, s99
  s_xor_b32 s66, s99, 0x8100
  buffer_load_dwordx4 v[72:75], v4, s[12:15], s97 offen offset:0 nt
  buffer_load_dwordx4 v[76:79], v4, s[12:15], s66 offen offset:0 nt
  buffer_load_dwordx4 v[80:83], v4, s[12:15], s97 offen offset:512 nt
  buffer_load_dwordx4 v[84:87], v4, s[12:15], s66 offen offset:512 nt
L_floop:
  s_cmp_lg_u32 s71, 0
  s_cbranch_scc1 L_have_28
  s_sub_u32 s82, 64, s83
  s_lshr_b32 s82, s82, 4
  s_min_u32 s82, s82, 4
  s_max_u32 s82, s82, 1
  s_mov_b32 s69, s82
  s_atomic_add s69, s[58:59], s70 glc
L_have_28:
  s_waitcnt vmcnt(4)
  v_mfma_f32_16x16x32_bf16 v[16:19], v[24:27], v[56:59], 0
  v_mfma_f32_16x16x32_bf16 v[16:19], v[28:31], v[60:63], v[16:19]
  v_mfma_f32_16x16x32_bf16 v[16:19], v[32:35], v[64:67], v[16:19]
  v_mfma_f32_16x16x32_bf16 v[16:19], v[36:39], v[68:71], v[16:19]
  s_nop 7
  v_mov_b32_dpp v10, v16 quad_perm:[0,0,0,0] row_mask:0xf bank_mask:0xf
  v_add_f32_dpp v10, v17, v10 quad_perm:[1,1,1,1] row_mask:0xf bank_mask:0xf
  v_add_f32_dpp v10, v18, v10 quad_perm:[2,2,2,2] row_mask:0xf bank_mask:0xf
  v_add_f32_dpp v10, v19, v10 quad_perm:[3,3,3,3] row_mask:0xf bank_mask:0xf
  v_cvt_pk_bf16_f32 v10, v10, v10
  v_and_b32 v10, s74, v10
  v_mul_f32 v10, s72, v10
  v_cvt_pk_bf16_f32 v10, v10, v10
  v_and_b32 v10, s74, v10
  v_cmp_gt_f32 vcc, v10, v5
  s_cbranch_vccnz L_rare_29
L_ret_30:
  v_fma_f32 v12, v10, s73, v6
  v_exp_f32 v12, v12
  s_nop 0
  v_cvt_pk_bf16_f32 v11, v12, v12
  v_and_b32 v11, v8, v11
  v_sub_f32 v11, v12, v11
  v_cvt_pk_bf16_f32 v11, v11, v11
  v_and_b32 v14, v9, v11
  v_add_f32 v7, v7, v12
  s_nop 0
  v_mov_b32_dpp v40, v14 quad_perm:[0,1,2,3] row_mask:0xf bank_mask:0x1
  v_mov_b32_dpp v41, v14 row_ror:4 row_mask:0xf bank_mask:0x2
  v_mov_b32_dpp v42, v14 row_ror:8 row_mask:0xf bank_mask:0x4
  v_mov_b32_dpp v43, v14 row_ror:12 row_mask:0xf bank_mask:0x8
  v_mov_b32_dpp v44, v14 row_ror:12 row_mask:0xf bank_mask:0x1
  v_mov_b32_dpp v45, v14 quad_perm:[0,1,2,3] row_mask:0xf bank_mask:0x2
  v_mov_b32_dpp v46, v14 row_ror:4 row_mask:0xf bank_mask:0x4
  v_mov_b32_dpp v47, v14 row_ror:8 row_mask:0xf bank_mask:0x8
  v_mov_b32_dpp v48, v14 row_ror:8 row_mask:0xf bank_mask:0x1
  v_mov_b32_dpp v49, v14 row_ror:12 row_mask:0xf bank_mask:0x2
  v_mov_b32_dpp v50, v14 quad_perm:[0,1,2,3] row_mask:0xf bank_mask:0x4
  v_mov_b32_dpp v51, v14 row_ror:4 row_mask:0xf bank_mask:0x8
  v_mov_b32_dpp v52, v14 row_ror:4 row_mask:0xf bank_mask:0x1
  v_mov_b32_dpp v53, v14 row_ror:8 row_mask:0xf bank_mask:0x2
  v_mov_b32_dpp v54, v14 row_ror:12 row_mask:0xf bank_mask:0x4
  v_mov_b32_dpp v55, v14 quad_perm:[0,1,2,3] row_mask:0xf bank_mask:0x8
  s_waitcnt vmcnt(0)
  s_cmp_lg_u32 s71, 0
  s_cbranch_scc1 L_next_31
  s_waitcnt lgkmcnt(0)
  s_sub_u32 s83, s69, 1
  s_mov_b32 s71, s82
L_next_31:
  s_add_u32 s83, s83, 1
  s_sub_u32 s71, s71, 1
  s_cmp_ge_u32 s83, 64
  s_cbranch_scc1 L_flast
  s_add_u32 s63, s83, 448
  s_and_b32 s64, s63, 7
  s_lshl_b32 s64, s64, 12
  s_add_u32 s64, s64, s68
  s_lshr_b32 s65, s63, 5
  s_lshl_b32 s65, s65, 17
  s_add_u32 s64, s64, s65
  s_and_b32 s65, s63, 8
  s_lshl_b32 s65, s65, 13
  s_add_u32 s67, s64, s65
  s_and_b32 s65, s63, 16
  s_lshl_b32 s65, s65, 4
  v_xor_b32 v156, s65, v3
  s_add_u32 s99, s67, s65
  buffer_load_dwordx4 v[56:59], v156, s[8:11], s67 offen offset:0 nt
  buffer_load_dwordx4 v[60:63], v156, s[8:11], s67 offen offset:1024 nt
  buffer_load_dwordx4 v[64:67], v156, s[8:11], s67 offen offset:2048 nt
  buffer_load_dwordx4 v[68:71], v156, s[8:11], s67 offen offset:3072 nt
  v_mfma_f32_16x16x32_bf16 v[20:23], v[72:75], v[40:43], v[20:23]
  v_mfma_f32_16x16x32_bf16 v[20:23], v[76:79], v[44:47], v[20:23]
  v_mfma_f32_16x16x32_bf16 v[20:23], v[80:83], v[48:51], v[20:23]
  v_mfma_f32_16x16x32_bf16 v[20:23], v[84:87], v[52:55], v[20:23]
  s_mov_b32 s97, s99
  s_xor_b32 s66, s99, 0x8100
  buffer_load_dwordx4 v[72:75], v4, s[12:15], s97 offen offset:0 nt
  buffer_load_dwordx4 v[76:79], v4, s[12:15], s66 offen offset:0 nt
  buffer_load_dwordx4 v[80:83], v4, s[12:15], s97 offen offset:512 nt
  buffer_load_dwordx4 v[84:87], v4, s[12:15], s66 offen offset:512 nt
  s_branch L_floop
L_flast:
  v_mfma_f32_16x16x32_bf16 v[20:23], v[72:75], v[40:43], v[20:23]
  v_mfma_f32_16x16x32_bf16 v[20:23], v[76:79], v[44:47], v[20:23]
  v_mfma_f32_16x16x32_bf16 v[20:23], v[80:83], v[48:51], v[20:23]
  v_mfma_f32_16x16x32_bf16 v[20:23], v[84:87], v[52:55], v[20:23]
  s_branch L_fin
L_last:
  v_and_b32 v10, s74, v154
  v_cmp_gt_f32 vcc, v10, v5
  s_cbranch_vccnz L_rare_32
L_ret_33:
  v_fma_f32 v12, v10, s73, v6
  v_exp_f32 v12, v12
  s_nop 0
  v_cvt_pk_bf16_f32 v11, v12, v12
  v_and_b32 v11, v8, v11
  v_sub_f32 v11, v12, v11
  v_cvt_pk_bf16_f32 v11, v11, v11
  v_and_b32 v14, v9, v11
  v_add_f32 v7, v7, v12
  s_nop 0
  v_mov_b32_dpp v40, v14 quad_perm:[0,1,2,3] row_mask:0xf bank_mask:0x1
  v_mov_b32_dpp v41, v14 row_ror:4 row_mask:0xf bank_mask:0x2
  v_mov_b32_dpp v42, v14 row_ror:8 row_mask:0xf bank_mask:0x4
  v_mov_b32_dpp v43, v14 row_ror:12 row_mask:0xf bank_mask:0x8
  v_mov_b32_dpp v44, v14 row_ror:12 row_mask:0xf bank_mask:0x1
  v_mov_b32_dpp v45, v14 quad_perm:[0,1,2,3] row_mask:0xf bank_mask:0x2
  v_mov_b32_dpp v46, v14 row_ror:4 row_mask:0xf bank_mask:0x4
  v_mov_b32_dpp v47, v14 row_ror:8 row_mask:0xf bank_mask:0x8
  v_mov_b32_dpp v48, v14 row_ror:8 row_mask:0xf bank_mask:0x1
  v_mov_b32_dpp v49, v14 row_ror:12 row_mask:0xf bank_mask:0x2
  v_mov_b32_dpp v50, v14 quad_perm:[0,1,2,3] row_mask:0xf bank_mask:0x4
  v_mov_b32_dpp v51, v14 row_ror:4 row_mask:0xf bank_mask:0x8
  v_mov_b32_dpp v52, v14 row_ror:4 row_mask:0xf bank_mask:0x1
  v_mov_b32_dpp v53, v14 row_ror:8 row_mask:0xf bank_mask:0x2
  v_mov_b32_dpp v54, v14 row_ror:12 row_mask:0xf bank_mask:0x4
  v_mov_b32_dpp v55, v14 quad_perm:[0,1,2,3] row_mask:0xf bank_mask:0x8
  s_waitcnt vmcnt(0)
  v_mfma_f32_16x16x32_bf16 v[20:23], v[72:75], v[40:43], v[20:23]
  v_mfma_f32_16x16x32_bf16 v[20:23], v[76:79], v[44:47], v[20:23]
  v_mfma_f32_16x16x32_bf16 v[20:23], v[80:83], v[48:51], v[20:23]
  v_mfma_f32_16x16x32_bf16 v[20:23], v[84:87], v[52:55], v[20:23]
L_fin:
  v_add_f32_dpp v7, v7, v7 row_ror:4 row_mask:0xf bank_mask:0xf
  s_nop 1
  v_add_f32_dpp v7, v7, v7 row_ror:8 row_mask:0xf bank_mask:0xf
  s_nop 1
  v_mov_b32 v13, v7
  v_cmp_ne_u32 vcc, 0, v8
  v_cmp_gt_i32 s[82:83], 0, v9
  v_permlane16_swap_b32 v13, v7
  v_add_f32_dpp v16, v20, v20 quad_perm:[2,3,0,1] row_mask:0xf bank_mask:0xf
  v_add_f32_dpp v17, v21, v21 quad_perm:[2,3,0,1] row_mask:0xf bank_mask:0xf
  v_add_f32 v7, v7, v13
  v_mov_b32 v13, v7
  v_add_f32_dpp v18, v22, v22 quad_perm:[2,3,0,1] row_mask:0xf bank_mask:0xf
  v_add_f32_dpp v19, v23, v23 quad_perm:[2,3,0,1] row_mask:0xf bank_mask:0xf
  v_permlane32_swap_b32 v13, v7
  v_sub_f32 v14, 0, v6
  v_cndmask_b32 v16, v16, v18, vcc
  v_cndmask_b32 v17, v17, v19, vcc
  v_add_u32 v16, 0x80, v16
  v_add_u32 v17, 0x80, v17
  s_mov_b32 s66, 0xffffff00
  v_lshlrev_b32 v154, 3, v0
  v_and_or_b32 v16, v16, s66, v128
  v_and_or_b32 v17, v17, s66, v129
  buffer_store_dwordx2 v[16:17], v154, s[24:27], s92 offen sc1
  v_mov_b32 v20, v14
  v_add_f32 v21, v7, v13
  v_mov_b32 v22, s75
  v_mov_b32 v23, s75
  s_mov_b64 exec, 15
  buffer_store_dwordx4 v[20:23], v120, s[24:27], s92 offen offset:512 sc1
  s_mov_b64 exec, -1
  s_add_u32 s92, s93, 4096
  v_lshlrev_b32 v155, 8, v133
  s_barrier
  buffer_load_dwordx4 v[36:39], v155, s[24:27], s93 offen offset:512 sc1
  buffer_load_dwordx2 v[56:57], v154, s[24:27], s93 offen offset:0 sc1
  buffer_load_dwordx2 v[58:59], v154, s[24:27], s93 offen offset:1024 sc1
  buffer_load_dwordx2 v[60:61], v154, s[24:27], s93 offen offset:2048 sc1
  buffer_load_dwordx2 v[62:63], v154, s[24:27], s93 offen offset:3072 sc1
  buffer_load_dwordx2 v[64:65], v154, s[24:27], s92 offen offset:0 sc1
  buffer_load_dwordx2 v[66:67], v154, s[24:27], s92 offen offset:1024 sc1
  buffer_load_dwordx2 v[68:69], v154, s[24:27], s92 offen offset:2048 sc1
  buffer_load_dwordx2 v[70:71], v154, s[24:27], s92 offen offset:3072 sc1
  ds_read_b64_tr_b16 v[88:89], v121 offset:0
  ds_read_b64_tr_b16 v[90:91], v121 offset:576
  ds_read_b64_tr_b16 v[92:93], v121 offset:4608
  ds_read_b64_tr_b16 v[94:95], v121 offset:5184
  ds_read_b64_tr_b16 v[96:97], v121 offset:9216
  ds_read_b64_tr_b16 v[98:99], v121 offset:9792
  ds_read_b64_tr_b16 v[100:101], v121 offset:13824
  ds_read_b64_tr_b16 v[102:103], v121 offset:14400
  s_waitcnt lgkmcnt(4)
  ds_read_b64_tr_b16 v[104:105], v122 offset:128
  ds_read_b64_tr_b16 v[106:107], v122 offset:704
  ds_read_b64_tr_b16 v[108:109], v122 offset:4736
  ds_read_b64_tr_b16 v[110:111], v122 offset:5312
  ds_read_b64_tr_b16 v[112:113], v122 offset:9344
  ds_read_b64_tr_b16 v[114:115], v122 offset:9920
  ds_read_b64_tr_b16 v[116:117], v122 offset:13952
  ds_read_b64_tr_b16 v[118:119], v122 offset:14528
  s_mul_i32 s94, s87, 9216
  s_mul_i32 s64, s88, 288
  s_add_u32 s94, s94, s64
  s_add_u32 s94, s94, 0x100000
  s_lshl_b32 s95, s62, 6
  s_add_u32 s95, s95, s94
L_poll1:
  s_waitcnt vmcnt(0)
  v_max_f32_dpp v10, v36, v36 row_ror:1 row_mask:0xf bank_mask:0xf
  v_xor_b32 v72, v56, v128
  v_xor_b32 v73, v57, v129
  v_or_b32 v24, v72, v73
  v_max_f32_dpp v10, v10, v10 row_ror:2 row_mask:0xf bank_mask:0xf
  v_xor_b32 v74, v58, v128
  v_xor_b32 v75, v59, v129
  v_or_b32 v25, v74, v75
  v_max_f32_dpp v10, v10, v10 row_ror:4 row_mask:0xf bank_mask:0xf
  v_sub_f32 v13, v36, v10
  v_exp_f32 v13, v13
  v_xor_b32 v76, v60, v128
  v_xor_b32 v77, v61, v129
  v_or_b32 v26, v76, v77
  v_mul_f32 v11, v13, v37
  v_xor_b32 v78, v62, v128
  v_xor_b32 v79, v63, v129
  v_or_b32 v27, v78, v79
  v_add_f32_dpp v11, v11, v11 row_ror:1 row_mask:0xf bank_mask:0xf
  v_xor_b32 v80, v64, v128
  v_xor_b32 v81, v65, v129
  v_or_b32 v28, v80, v81
  v_add_f32_dpp v11, v11, v11 row_ror:2 row_mask:0xf bank_mask:0xf
  v_xor_b32 v82, v66, v128
  v_xor_b32 v83, v67, v129
  v_or_b32 v29, v82, v83
  v_add_f32_dpp v11, v11, v11 row_ror:4 row_mask:0xf bank_mask:0xf
  v_rcp_f32 v11, v11
  v_xor_b32 v84, v68, v128
  v_xor_b32 v85, v69, v129
  v_or_b32 v30, v84, v85
  v_mul_f32 v13, v13, v11
  v_xor_b32 v86, v70, v128
  v_xor_b32 v87, v71, v129
  v_or_b32 v31, v86, v87
  v_or3_b32 v12, v24, v25, v26
  v_or3_b32 v10, v27, v28, v29
  v_or3_b32 v12, v12, v30, v31
  v_or_b32 v12, v12, v10
  v_xor_b32 v10, s75, v38
  v_and_b32 v12, 0xff, v12
  v_or_b32 v12, v12, v10
  v_cmp_ne_u32 vcc, 0, v12
  s_cbranch_vccnz L_poll1_more
L_poll1_done:
  v_mul_f32_dpp v14, v13, v72 row_newbcast:0 row_mask:0xf bank_mask:0xf
  v_mul_f32_dpp v15, v13, v73 row_newbcast:0 row_mask:0xf bank_mask:0xf
  v_fmac_f32_dpp v14, v13, v74 row_newbcast:1 row_mask:0xf bank_mask:0xf
  v_fmac_f32_dpp v15, v13, v75 row_newbcast:1 row_mask:0xf bank_mask:0xf
  v_fmac_f32_dpp v14, v13, v76 row_newbcast:2 row_mask:0xf bank_mask:0xf
  v_fmac_f32_dpp v15, v13, v77 row_newbcast:2 row_mask:0xf bank_mask:0xf
  v_fmac_f32_dpp v14, v13, v78 row_newbcast:3 row_mask:0xf bank_mask:0xf
  v_fmac_f32_dpp v15, v13, v79 row_newbcast:3 row_mask:0xf bank_mask:0xf
  v_fmac_f32_dpp v14, v13, v80 row_newbcast:4 row_mask:0xf bank_mask:0xf
  v_fmac_f32_dpp v15, v13, v81 row_newbcast:4 row_mask:0xf bank_mask:0xf
  v_fmac_f32_dpp v14, v13, v82 row_newbcast:5 row_mask:0xf bank_mask:0xf
  v_fmac_f32_dpp v15, v13, v83 row_newbcast:5 row_mask:0xf bank_mask:0xf
  v_fmac_f32_dpp v14, v13, v84 row_newbcast:6 row_mask:0xf bank_mask:0xf
  v_fmac_f32_dpp v15, v13, v85 row_newbcast:6 row_mask:0xf bank_mask:0xf
  v_fmac_f32_dpp v14, v13, v86 row_newbcast:7 row_mask:0xf bank_mask:0xf
  v_fmac_f32_dpp v15, v13, v87 row_newbcast:7 row_mask:0xf bank_mask:0xf
  v_cvt_pk_bf16_f32 v14, v14, v15
  ds_write_b16 v123, v14 offset:5888
  ds_write_b16_d16_hi v123, v14 offset:5904
  s_waitcnt lgkmcnt(0)
  s_barrier
  ds_read_b128 v[24:27], v124 offset:5888
  ds_read_b128 v[28:31], v124 offset:5952
  ds_read_b128 v[32:35], v124 offset:6016
  ds_read_b128 v[36:39], v124 offset:6080
  s_waitcnt lgkmcnt(3)
  v_mfma_f32_16x16x32_bf16 v[16:19], v[88:91], v[24:27], 0
  v_mfma_f32_16x16x32_bf16 v[20:23], v[104:107], v[24:27], 0
  s_waitcnt lgkmcnt(2)
  v_mfma_f32_16x16x32_bf16 v[16:19], v[92:95], v[28:31], v[16:19]
  v_mfma_f32_16x16x32_bf16 v[20:23], v[108:111], v[28:31], v[20:23]
  s_waitcnt lgkmcnt(1)
  v_mfma_f32_16x16x32_bf16 v[16:19], v[96:99], v[32:35], v[16:19]
  v_mfma_f32_16x16x32_bf16 v[20:23], v[112:115], v[32:35], v[20:23]
  s_waitcnt lgkmcnt(0)
  v_mfma_f32_16x16x32_bf16 v[16:19], v[100:103], v[36:39], v[16:19]
  v_mfma_f32_16x16x32_bf16 v[20:23], v[116:119], v[36:39], v[20:23]
  s_cmp_eq_u32 s62, 0
  s_cselect_b32 s94, s94, 0x40000000
  s_mov_b64 exec, s[84:85]
  s_mov_b32 s66, 0xffffff00
  s_nop 2
  v_add_u32 v16, 0x80, v16
  v_add_u32 v17, 0x80, v17
  v_add_u32 v18, 0x80, v18
  v_add_u32 v19, 0x80, v19
  v_and_or_b32 v16, v16, s66, v128
  v_and_or_b32 v17, v17, s66, v129
  v_and_or_b32 v18, v18, s66, v130
  v_and_or_b32 v19, v19, s66, v131
  buffer_store_dwordx4 v[16:19], v125, s[24:27], s95 offen sc1
  v_add_u32 v20, 0x80, v20
  v_add_u32 v21, 0x80, v21
  v_add_u32 v22, 0x80, v22
  v_add_u32 v23, 0x80, v23
  v_and_or_b32 v20, v20, s66, v128
  v_and_or_b32 v21, v21, s66, v129
  v_and_or_b32 v22, v22, s66, v130
  v_and_or_b32 v23, v23, s66, v131
  s_mov_b32 exec_hi, 0
  buffer_store_dwordx4 v[20:23], v125, s[24:27], s94 offen offset:256 sc1
  s_mov_b64 exec, -1
  s_cmp_ge_u32 s2, 36
  s_cbranch_scc1 L_done
  s_mul_i32 s63, s62, 2304
  s_lshl_b32 s64, s2, 6
  s_add_u32 s63, s63, s64
  s_add_u32 s65, s63, 0x180000
  s_add_u32 s66, s63, 0x1a4000
  s_add_u32 s64, s63, 0x124000
  s_add_u32 s63, s63, 0x100000
  s_mul_i32 s67, s62, 1152
  s_lshl_b32 s68, s2, 5
  s_add_u32 s67, s67, s68
  buffer_load_ushort v5, v127, s[4:7], s67 offen
  s_mov_b32 s32, s54
  s_mov_b32 s33, s55
  s_mov_b32 s34, 0x1200
  s_mov_b32 s35, 0x20000
  buffer_load_dwordx4 v[24:27], v126, s[24:27], s65 offen sc1
  buffer_load_dwordx4 v[28:31], v126, s[24:27], s66 offen sc1
  buffer_load_dwordx4 v[32:35], v126, s[24:27], s63 offen sc1
  buffer_load_dwordx4 v[36:39], v126, s[24:27], s64 offen sc1
  s_waitcnt vmcnt(2)
L_redb:
  v_xor_b32 v24, v24, v128
  v_xor_b32 v25, v25, v129
  v_xor_b32 v26, v26, v130
  v_xor_b32 v27, v27, v131
  v_xor_b32 v28, v28, v128
  v_xor_b32 v29, v29, v129
  v_xor_b32 v30, v30, v130
  v_xor_b32 v31, v31, v131
  v_or3_b32 v10, v24, v25, v26
  v_or3_b32 v11, v27, v28, v29
  v_or3_b32 v10, v10, v30, v31
  v_or_b32 v10, v10, v11
  v_and_b32 v10, 0xff, v10
  v_cmp_ne_u32 vcc, 0, v10
  s_cbranch_vccnz L_redb_more
L_redb_done:
  v_add_f32 v24, v24, v28
  v_add_f32 v25, v25, v29
  v_add_f32 v26, v26, v30
  v_add_f32 v27, v27, v31
  s_nop 0
  v_permlane16_swap_b32 v24, v25
  v_permlane16_swap_b32 v26, v27
  s_nop 0
  v_add_f32 v24, v24, v25
  v_add_f32 v26, v26, v27
  s_nop 1
  v_permlane32_swap_b32 v24, v26
  s_nop 1
  v_add_f32 v6, v24, v26
  s_nop 1
  v_add_f32_dpp v6, v6, v6 row_ror:4 row_mask:0xf bank_mask:0xf
  s_nop 1
  v_add_f32_dpp v6, v6, v6 row_ror:8 row_mask:0xf bank_mask:0xf
  v_cvt_pk_bf16_f32 v6, v6, v6
  v_and_b32 v6, s74, v6
  v_lshlrev_b32 v5, 16, v5
  s_waitcnt vmcnt(0)
L_reda:
  v_xor_b32 v32, v32, v128
  v_xor_b32 v33, v33, v129
  v_xor_b32 v34, v34, v130
  v_xor_b32 v35, v35, v131
  v_xor_b32 v36, v36, v128
  v_xor_b32 v37, v37, v129
  v_xor_b32 v38, v38, v130
  v_xor_b32 v39, v39, v131
  v_or3_b32 v10, v32, v33, v34
  v_or3_b32 v11, v35, v36, v37
  v_or3_b32 v10, v10, v38, v39
  v_or_b32 v10, v10, v11
  v_and_b32 v10, 0xff, v10
  v_cmp_ne_u32 vcc, 0, v10
  s_cbranch_vccnz L_reda_more
L_reda_done:
  v_add_f32 v32, v32, v36
  v_add_f32 v33, v33, v37
  v_add_f32 v34, v34, v38
  v_add_f32 v35, v35, v39
  s_nop 0
  v_permlane16_swap_b32 v32, v33
  v_permlane16_swap_b32 v34, v35
  s_nop 0
  v_add_f32 v32, v32, v33
  v_add_f32 v34, v34, v35
  s_nop 1
  v_permlane32_swap_b32 v32, v34
  s_nop 1
  v_add_f32 v7, v32, v34
  s_nop 1
  v_add_f32_dpp v7, v7, v7 row_ror:4 row_mask:0xf bank_mask:0xf
  s_nop 1
  v_add_f32_dpp v7, v7, v7 row_ror:8 row_mask:0xf bank_mask:0xf
  v_cvt_pk_bf16_f32 v7, v7, v7
  v_and_b32 v7, s74, v7
  v_add_f32 v7, v7, v5
  v_cvt_pk_bf16_f32 v7, v7, v7
  v_and_b32 v7, s74, v7
  v_add_f32 v7, v7, v6
  v_cvt_pk_bf16_f32 v7, v7, v7
  s_mov_b64 exec, s[84:85]
  buffer_store_short v7, v127, s[32:35], s67 offen
  s_or_b32 s63, s2, s62
  s_cmp_lg_u32 s63, 0
  s_cbranch_scc1 L_done
  s_mov_b64 exec, 1
  v_mov_b32 v1, s75
  v_mov_b32 v2, 0x0
  buffer_store_dword v1, v2, s[24:27], 0 offen sc1
L_done:
L_end:
  s_endpgm
L_kmark:
  s_cmp_lt_u32 s71, 10
  s_cbranch_scc0 L_kmark10
  v_mov_b32 v11, 7168
  v_mov_b32 v13, 1
  s_mov_b64 exec, 1
  ds_add_u32 v11, v13 offset:12
  s_mov_b64 exec, -1
  s_branch L_kret
L_kmark10:
  s_cmp_eq_u32 s69, s101
  s_cbranch_scc0 L_kmark_o
  s_mov_b32 s94, 1
  s_atomic_add s94, s[58:59], s95 glc
  s_branch L_kret
L_kmark_o:
  s_cmp_eq_u32 s71, 10
  s_cbranch_scc0 L_kmark12
  s_mul_i32 s63, s81, 2560
  s_add_u32 s63, s63, 122112
  s_lshl_b32 s64, s69, 11
  v_add_u32 v11, s63, v120
  ds_read_b128 v[136:139], v11 offset:128
  v_add_u32 v13, s64, v120
  s_waitcnt lgkmcnt(0)
  buffer_store_dwordx4 v[136:139], v13, s[24:27], s89 offen offset:128 sc1 nt
  s_branch L_kret
L_kmark12:
  s_cmp_eq_u32 s71, 11
  s_cbranch_scc0 L_kmark14
  s_lshl_b32 s63, s69, 2
  s_add_u32 s63, s63, s80
  v_mov_b32 v11, s75
  v_mov_b32 v13, 0
  s_mov_b64 exec, 1
  buffer_store_dword v11, v13, s[24:27], s63 offen offset:0 sc1
  s_mov_b64 exec, -1
  s_branch L_kret
L_kmark14:
  s_mov_b32 s94, 1
  s_atomic_add s94, s[58:59], s95 glc
  s_lshl_b32 s66, s101, 2
  s_add_u32 s66, s66, s80
  v_mov_b32 v13, 0
  buffer_load_dword v132, v13, s[24:27], s66 offen offset:0 sc1
  s_branch L_kret
L_vmark:
  s_cmp_eq_u32 s69, s101
  s_cbranch_scc0 L_vm_opp
  s_cmp_lt_u32 s71, 12
  s_cbranch_scc1 L_vm_s
  s_and_b32 s65, s93, 15
  s_lshr_b32 s93, s93, 4
  s_lshr_b32 s63, s65, 2
  s_add_u32 s63, s63, 13
  s_lshl_b32 s63, s63, 5
  s_and_b32 s64, s65, 1
  s_or_b32 s63, s63, s64
  s_and_b32 s64, s65, 2
  s_lshl_b32 s64, s64, 1
  s_or_b32 s63, s63, s64
  s_and_b32 s64, s69, 2
  s_or_b32 s63, s63, s64
  s_lshl_b32 s63, s63, 12
  s_add_u32 s63, s63, s68
  s_sub_u32 s96, s63, s99
  s_branch L_vret
L_vm_s:
  s_cmp_gt_u32 s71, 1
  s_cbranch_scc1 L_vm_late
  s_sub_u32 s63, s69, s61
  s_lshl_b32 s63, s63, 12
  s_cmp_eq_u32 s71, 0
  s_cselect_b32 s63, s63, 0
  s_add_u32 s96, s63, 0x20000
  s_branch L_vret
L_vm_late:
  v_mov_b32 v11, 7168
  v_mov_b32 v13, 1
  s_mov_b64 exec, 1
  ds_add_u32 v11, v13 offset:16
  s_mov_b64 exec, -1
  s_branch L_vret
L_vm_opp:
  s_cmp_eq_u32 s71, 6
  s_cbranch_scc1 L_vm_late
  s_cmp_eq_u32 s71, 2
  s_cbranch_scc0 L_vm8
  s_lshl_b32 s63, s69, 2
  s_add_u32 s63, s63, s80
  v_mov_b32 v11, s75
  v_mov_b32 v13, 0
  s_mov_b64 exec, 1
  buffer_store_dword v11, v13, s[24:27], s63 offen offset:128 sc1
  s_mov_b64 exec, -1
  s_branch L_vret
L_vm8:
  s_cmp_eq_u32 s71, 7
  s_cbranch_scc0 L_vm9
  buffer_load_dword v132, v133, s[24:27], s80 offen offset:128 sc1
  s_branch L_vret
L_vm9:
L_fb:
  v_cmp_ne_u32 vcc, s75, v132
  s_cbranch_vccz L_fb_ok
  s_sub_u32 s76, s76, 1
  s_cmp_le_i32 s76, 0
  s_cbranch_scc1 L_fb_ok
  s_sleep 4
  buffer_load_dword v132, v133, s[24:27], s80 offen offset:128 sc1
  s_waitcnt vmcnt(0)
  s_branch L_fb
L_fb_ok:
  s_mul_i32 s63, s81, 2560
  s_add_u32 s63, s63, 122112
  s_add_u32 m0, s63, 1152
  s_lshl_b32 s64, s101, 11
  s_add_u32 s64, s64, s89
  s_add_u32 s64, s64, 1152
  s_mov_b32 exec_lo, 0xffffffff
  s_mov_b32 exec_hi, 0x0
  buffer_load_dwordx4 v120, s[24:27], s64 offen sc1 nt lds
  s_mov_b64 exec, -1
  s_branch L_vret
L_rare_1:
  v_max_f32_dpp v11, v10, v10 row_ror:4 row_mask:0xf bank_mask:0xf
  s_nop 1
  v_max_f32_dpp v11, v11, v11 row_ror:8 row_mask:0xf bank_mask:0xf
  v_mov_b32 v13, v11
  s_nop 1
  v_permlane16_swap_b32 v13, v11
  s_nop 1
  v_max_f32 v11, v11, v13
  v_mov_b32 v13, v11
  s_nop 1
  v_permlane32_swap_b32 v13, v11
  s_nop 1
  v_max3_f32 v5, v11, v13, v5
  v_mul_f32 v13, s73, v5
  v_add_f32 v11, v6, v13
  v_exp_f32 v11, -v11
  v_sub_f32 v6, 0, v13
  v_mul_f32 v7, v7, v11
  v_mul_f32 v20, v20, v11
  v_mul_f32 v21, v21, v11
  v_mul_f32 v22, v22, v11
  v_mul_f32 v23, v23, v11
  s_branch L_ret_2
L_rare_3:
  v_max_f32_dpp v11, v10, v10 row_ror:4 row_mask:0xf bank_mask:0xf
  s_nop 1
  v_max_f32_dpp v11, v11, v11 row_ror:8 row_mask:0xf bank_mask:0xf
  v_mov_b32 v13, v11
  s_nop 1
  v_permlane16_swap_b32 v13, v11
  s_nop 1
  v_max_f32 v11, v11, v13
  v_mov_b32 v13, v11
  s_nop 1
  v_permlane32_swap_b32 v13, v11
  s_nop 1
  v_max3_f32 v5, v11, v13, v5
  v_mul_f32 v13, s73, v5
  v_add_f32 v11, v6, v13
  v_exp_f32 v11, -v11
  v_sub_f32 v6, 0, v13
  v_mul_f32 v7, v7, v11
  v_mul_f32 v20, v20, v11
  v_mul_f32 v21, v21, v11
  v_mul_f32 v22, v22, v11
  v_mul_f32 v23, v23, v11
  s_branch L_ret_4
L_rare_5:
  v_max_f32_dpp v11, v10, v10 row_ror:4 row_mask:0xf bank_mask:0xf
  s_nop 1
  v_max_f32_dpp v11, v11, v11 row_ror:8 row_mask:0xf bank_mask:0xf
  v_mov_b32 v13, v11
  s_nop 1
  v_permlane16_swap_b32 v13, v11
  s_nop 1
  v_max_f32 v11, v11, v13
  v_mov_b32 v13, v11
  s_nop 1
  v_permlane32_swap_b32 v13, v11
  s_nop 1
  v_max3_f32 v5, v11, v13, v5
  v_mul_f32 v13, s73, v5
  v_add_f32 v11, v6, v13
  v_exp_f32 v11, -v11
  v_sub_f32 v6, 0, v13
  v_mul_f32 v7, v7, v11
  v_mul_f32 v20, v20, v11
  v_mul_f32 v21, v21, v11
  v_mul_f32 v22, v22, v11
  v_mul_f32 v23, v23, v11
  s_branch L_ret_6
L_rare_7:
  v_max_f32_dpp v11, v10, v10 row_ror:4 row_mask:0xf bank_mask:0xf
  s_nop 1
  v_max_f32_dpp v11, v11, v11 row_ror:8 row_mask:0xf bank_mask:0xf
  v_mov_b32 v13, v11
  s_nop 1
  v_permlane16_swap_b32 v13, v11
  s_nop 1
  v_max_f32 v11, v11, v13
  v_mov_b32 v13, v11
  s_nop 1
  v_permlane32_swap_b32 v13, v11
  s_nop 1
  v_max3_f32 v5, v11, v13, v5
  v_mul_f32 v13, s73, v5
  v_add_f32 v11, v6, v13
  v_exp_f32 v11, -v11
  v_sub_f32 v6, 0, v13
  v_mul_f32 v7, v7, v11
  v_mul_f32 v20, v20, v11
  v_mul_f32 v21, v21, v11
  v_mul_f32 v22, v22, v11
  v_mul_f32 v23, v23, v11
  s_branch L_ret_8
L_rare_9:
  v_max_f32_dpp v11, v10, v10 row_ror:4 row_mask:0xf bank_mask:0xf
  s_nop 1
  v_max_f32_dpp v11, v11, v11 row_ror:8 row_mask:0xf bank_mask:0xf
  v_mov_b32 v13, v11
  s_nop 1
  v_permlane16_swap_b32 v13, v11
  s_nop 1
  v_max_f32 v11, v11, v13
  v_mov_b32 v13, v11
  s_nop 1
  v_permlane32_swap_b32 v13, v11
  s_nop 1
  v_max3_f32 v5, v11, v13, v5
  v_mul_f32 v13, s73, v5
  v_add_f32 v11, v6, v13
  v_exp_f32 v11, -v11
  v_sub_f32 v6, 0, v13
  v_mul_f32 v7, v7, v11
  v_mul_f32 v20, v20, v11
  v_mul_f32 v21, v21, v11
  v_mul_f32 v22, v22, v11
  v_mul_f32 v23, v23, v11
  s_branch L_ret_10
L_rare_11:
  v_max_f32_dpp v11, v10, v10 row_ror:4 row_mask:0xf bank_mask:0xf
  s_nop 1
  v_max_f32_dpp v11, v11, v11 row_ror:8 row_mask:0xf bank_mask:0xf
  v_mov_b32 v13, v11
  s_nop 1
  v_permlane16_swap_b32 v13, v11
  s_nop 1
  v_max_f32 v11, v11, v13
  v_mov_b32 v13, v11
  s_nop 1
  v_permlane32_swap_b32 v13, v11
  s_nop 1
  v_max3_f32 v5, v11, v13, v5
  v_mul_f32 v13, s73, v5
  v_add_f32 v11, v6, v13
  v_exp_f32 v11, -v11
  v_sub_f32 v6, 0, v13
  v_mul_f32 v7, v7, v11
  v_mul_f32 v20, v20, v11
  v_mul_f32 v21, v21, v11
  v_mul_f32 v22, v22, v11
  v_mul_f32 v23, v23, v11
  s_branch L_ret_12
L_rare_13:
  v_max_f32_dpp v11, v10, v10 row_ror:4 row_mask:0xf bank_mask:0xf
  s_nop 1
  v_max_f32_dpp v11, v11, v11 row_ror:8 row_mask:0xf bank_mask:0xf
  v_mov_b32 v13, v11
  s_nop 1
  v_permlane16_swap_b32 v13, v11
  s_nop 1
  v_max_f32 v11, v11, v13
  v_mov_b32 v13, v11
  s_nop 1
  v_permlane32_swap_b32 v13, v11
  s_nop 1
  v_max3_f32 v5, v11, v13, v5
  v_mul_f32 v13, s73, v5
  v_add_f32 v11, v6, v13
  v_exp_f32 v11, -v11
  v_sub_f32 v6, 0, v13
  v_mul_f32 v7, v7, v11
  v_mul_f32 v20, v20, v11
  v_mul_f32 v21, v21, v11
  v_mul_f32 v22, v22, v11
  v_mul_f32 v23, v23, v11
  s_branch L_ret_14
L_rare_17:
  v_max_f32_dpp v11, v10, v10 row_ror:4 row_mask:0xf bank_mask:0xf
  s_nop 1
  v_max_f32_dpp v11, v11, v11 row_ror:8 row_mask:0xf bank_mask:0xf
  v_mov_b32 v13, v11
  s_nop 1
  v_permlane16_swap_b32 v13, v11
  s_nop 1
  v_max_f32 v11, v11, v13
  v_mov_b32 v13, v11
  s_nop 1
  v_permlane32_swap_b32 v13, v11
  s_nop 1
  v_max3_f32 v5, v11, v13, v5
  v_mul_f32 v13, s73, v5
  v_add_f32 v11, v6, v13
  v_exp_f32 v11, -v11
  v_sub_f32 v6, 0, v13
  v_mul_f32 v7, v7, v11
  v_mul_f32 v20, v20, v11
  v_mul_f32 v21, v21, v11
  v_mul_f32 v22, v22, v11
  v_mul_f32 v23, v23, v11
  s_branch L_ret_18
L_rare_19:
  v_max_f32_dpp v11, v10, v10 row_ror:4 row_mask:0xf bank_mask:0xf
  s_nop 1
  v_max_f32_dpp v11, v11, v11 row_ror:8 row_mask:0xf bank_mask:0xf
  v_mov_b32 v13, v11
  s_nop 1
  v_permlane16_swap_b32 v13, v11
  s_nop 1
  v_max_f32 v11, v11, v13
  v_mov_b32 v13, v11
  s_nop 1
  v_permlane32_swap_b32 v13, v11
  s_nop 1
  v_max3_f32 v5, v11, v13, v5
  v_mul_f32 v13, s73, v5
  v_add_f32 v11, v6, v13
  v_exp_f32 v11, -v11
  v_sub_f32 v6, 0, v13
  v_mul_f32 v7, v7, v11
  v_mul_f32 v20, v20, v11
  v_mul_f32 v21, v21, v11
  v_mul_f32 v22, v22, v11
  v_mul_f32 v23, v23, v11
  s_branch L_ret_20
L_rare_23:
  v_max_f32_dpp v11, v10, v10 row_ror:4 row_mask:0xf bank_mask:0xf
  s_nop 1
  v_max_f32_dpp v11, v11, v11 row_ror:8 row_mask:0xf bank_mask:0xf
  v_mov_b32 v13, v11
  s_nop 1
  v_permlane16_swap_b32 v13, v11
  s_nop 1
  v_max_f32 v11, v11, v13
  v_mov_b32 v13, v11
  s_nop 1
  v_permlane32_swap_b32 v13, v11
  s_nop 1
  v_max3_f32 v5, v11, v13, v5
  v_mul_f32 v13, s73, v5
  v_add_f32 v11, v6, v13
  v_exp_f32 v11, -v11
  v_sub_f32 v6, 0, v13
  v_mul_f32 v7, v7, v11
  v_mul_f32 v20, v20, v11
  v_mul_f32 v21, v21, v11
  v_mul_f32 v22, v22, v11
  v_mul_f32 v23, v23, v11
  s_branch L_ret_24
L_rare_26:
  v_max_f32_dpp v11, v10, v10 row_ror:4 row_mask:0xf bank_mask:0xf
  s_nop 1
  v_max_f32_dpp v11, v11, v11 row_ror:8 row_mask:0xf bank_mask:0xf
  v_mov_b32 v13, v11
  s_nop 1
  v_permlane16_swap_b32 v13, v11
  s_nop 1
  v_max_f32 v11, v11, v13
  v_mov_b32 v13, v11
  s_nop 1
  v_permlane32_swap_b32 v13, v11
  s_nop 1
  v_max3_f32 v5, v11, v13, v5
  v_mul_f32 v13, s73, v5
  v_add_f32 v11, v6, v13
  v_exp_f32 v11, -v11
  v_sub_f32 v6, 0, v13
  v_mul_f32 v7, v7, v11
  v_mul_f32 v20, v20, v11
  v_mul_f32 v21, v21, v11
  v_mul_f32 v22, v22, v11
  v_mul_f32 v23, v23, v11
  s_branch L_ret_27
L_rare_29:
  v_max_f32_dpp v11, v10, v10 row_ror:4 row_mask:0xf bank_mask:0xf
  s_nop 1
  v_max_f32_dpp v11, v11, v11 row_ror:8 row_mask:0xf bank_mask:0xf
  v_mov_b32 v13, v11
  s_nop 1
  v_permlane16_swap_b32 v13, v11
  s_nop 1
  v_max_f32 v11, v11, v13
  v_mov_b32 v13, v11
  s_nop 1
  v_permlane32_swap_b32 v13, v11
  s_nop 1
  v_max3_f32 v5, v11, v13, v5
  v_mul_f32 v13, s73, v5
  v_add_f32 v11, v6, v13
  v_exp_f32 v11, -v11
  v_sub_f32 v6, 0, v13
  v_mul_f32 v7, v7, v11
  v_mul_f32 v20, v20, v11
  v_mul_f32 v21, v21, v11
  v_mul_f32 v22, v22, v11
  v_mul_f32 v23, v23, v11
  s_branch L_ret_30
L_rare_32:
  v_max_f32_dpp v11, v10, v10 row_ror:4 row_mask:0xf bank_mask:0xf
  s_nop 1
  v_max_f32_dpp v11, v11, v11 row_ror:8 row_mask:0xf bank_mask:0xf
  v_mov_b32 v13, v11
  s_nop 1
  v_permlane16_swap_b32 v13, v11
  s_nop 1
  v_max_f32 v11, v11, v13
  v_mov_b32 v13, v11
  s_nop 1
  v_permlane32_swap_b32 v13, v11
  s_nop 1
  v_max3_f32 v5, v11, v13, v5
  v_mul_f32 v13, s73, v5
  v_add_f32 v11, v6, v13
  v_exp_f32 v11, -v11
  v_sub_f32 v6, 0, v13
  v_mul_f32 v7, v7, v11
  v_mul_f32 v20, v20, v11
  v_mul_f32 v21, v21, v11
  v_mul_f32 v22, v22, v11
  v_mul_f32 v23, v23, v11
  s_branch L_ret_33
L_poll1_more:
  s_sub_u32 s76, s76, 1
  s_cmp_le_i32 s76, 0
  s_cbranch_scc1 L_poll1_done
  v_cmp_ne_u32 vcc, 0, v10
  s_and_saveexec_b64 s[82:83], vcc
  s_cbranch_execz L_p1skipm
  buffer_load_dwordx4 v[36:39], v155, s[24:27], s93 offen offset:512 sc1
L_p1skipm:
  s_mov_b64 exec, -1
  v_and_b32 v12, 0xff, v24
  v_cmp_ne_u32 vcc, 0, v12
  s_cbranch_vccz L_p1skip0
  buffer_load_dwordx2 v[56:57], v154, s[24:27], s93 offen offset:0 sc1
L_p1skip0:
  v_and_b32 v12, 0xff, v25
  v_cmp_ne_u32 vcc, 0, v12
  s_cbranch_vccz L_p1skip1
  buffer_load_dwordx2 v[58:59], v154, s[24:27], s93 offen offset:1024 sc1
L_p1skip1:
  v_and_b32 v12, 0xff, v26
  v_cmp_ne_u32 vcc, 0, v12
  s_cbranch_vccz L_p1skip2
  buffer_load_dwordx2 v[60:61], v154, s[24:27], s93 offen offset:2048 sc1
L_p1skip2:
  v_and_b32 v12, 0xff, v27
  v_cmp_ne_u32 vcc, 0, v12
  s_cbranch_vccz L_p1skip3
  buffer_load_dwordx2 v[62:63], v154, s[24:27], s93 offen offset:3072 sc1
L_p1skip3:
  v_and_b32 v12, 0xff, v28
  v_cmp_ne_u32 vcc, 0, v12
  s_cbranch_vccz L_p1skip4
  buffer_load_dwordx2 v[64:65], v154, s[24:27], s92 offen offset:0 sc1
L_p1skip4:
  v_and_b32 v12, 0xff, v29
  v_cmp_ne_u32 vcc, 0, v12
  s_cbranch_vccz L_p1skip5
  buffer_load_dwordx2 v[66:67], v154, s[24:27], s92 offen offset:1024 sc1
L_p1skip5:
  v_and_b32 v12, 0xff, v30
  v_cmp_ne_u32 vcc, 0, v12
  s_cbranch_vccz L_p1skip6
  buffer_load_dwordx2 v[68:69], v154, s[24:27], s92 offen offset:2048 sc1
L_p1skip6:
  v_and_b32 v12, 0xff, v31
  v_cmp_ne_u32 vcc, 0, v12
  s_cbranch_vccz L_p1skip7
  buffer_load_dwordx2 v[70:71], v154, s[24:27], s92 offen offset:3072 sc1
L_p1skip7:
  s_branch L_poll1
L_redb_more:
  s_sub_u32 s76, s76, 1
  s_cmp_le_i32 s76, 0
  s_cbranch_scc1 L_redb_done
  buffer_load_dwordx4 v[24:27], v126, s[24:27], s65 offen sc1
  buffer_load_dwordx4 v[28:31], v126, s[24:27], s66 offen sc1
  s_waitcnt vmcnt(0)
  s_branch L_redb
L_reda_more:
  s_sub_u32 s76, s76, 1
  s_cmp_le_i32 s76, 0
  s_cbranch_scc1 L_reda_done
  buffer_load_dwordx4 v[32:35], v126, s[24:27], s63 offen sc1
  buffer_load_dwordx4 v[36:39], v126, s[24:27], s64 offen sc1
  s_waitcnt vmcnt(0)
  s_branch L_reda
.section .rodata,"a"
.p2align 6
.amdhsa_kernel parallel_sum__mha_block_cached__geglu_ffn__decode_kernel
  .amdhsa_next_free_vgpr 192
  .amdhsa_next_free_sgpr 102
  .amdhsa_accum_offset 192
  .amdhsa_group_segment_fixed_size 0
  .amdhsa_kernarg_size 96
  .amdhsa_user_sgpr_count 2
  .amdhsa_user_sgpr_kernarg_segment_ptr 1
  .amdhsa_system_sgpr_workgroup_id_x 1
  .amdhsa_float_denorm_mode_32 3
.end_amdhsa_kernel
```
